```python
import torch

def _softmax(x, axis=-1):
    return torch.softmax(x, dim=axis)

def _gelu(x):
    return torch.nn.functional.gelu(x, approximate='tanh')

def _silu(x):
    return torch.nn.functional.silu(x)

def _sigmoid(x):
    return torch.sigmoid(x)

def _layernorm(x, axis=-1, eps=1e-05):
    m = x.mean(dim=axis, keepdim=True)
    v = x.var(dim=axis, keepdim=True, unbiased=False)
    return (x - m) / torch.sqrt(v + eps)

def _scatter_add(tgt, idx, src, axis=0):
    return tgt.clone().index_add_(axis, idx, src)

def _segment_sum(src, seg, n):
    out = torch.zeros((n,) + src.shape[1:], dtype=src.dtype)
    return out.index_add_(0, seg, src)

def _pad(x, pw):
    flat = tuple((v for pair in reversed(pw) for v in pair))
    return torch.nn.functional.pad(x, flat)
kernel_name = 'recurrent_scan__ssm_conv_h3__mixer_gmlp__prompt'

def setup_inputs():

    _w = lambda a: (lambda t: t.to(torch.bfloat16) if t.is_floating_point() else t)(torch.as_tensor(a))

    def _A_setup():
        B, S, D = (1, 2048, 448)
        ks = 4
        return {'q': _w((lambda *s: torch.randn(*s, dtype=torch.bfloat16) * 0.05)(B, S, D)), 'k': _w((lambda *s: torch.randn(*s, dtype=torch.bfloat16) * 0.2)(B, S, D)), 'v': _w((lambda *s: torch.randn(*s, dtype=torch.bfloat16) * 0.2)(B, S, D)), 'shift_k': _w((lambda *s: torch.randn(*s, dtype=torch.bfloat16) * 0.2)(D, ks) * 0.5), 'ssm_k': _w((lambda *s: torch.randn(*s, dtype=torch.bfloat16) * 0.2)(D, S) * (1.0 / S ** 0.5)), 'ssm_D': _w((lambda *s: torch.randn(*s, dtype=torch.bfloat16) * 0.2)(D))}
    _A_in = _A_setup()

    def _B_setup():
        B, S, D, F = (1, 2048, 448, 1792)
        Fh = F // 2
        return {'x': _w((lambda *s: torch.randn(*s, dtype=torch.bfloat16) * 0.05)(B, S, D)), 'w_in': _w((lambda *s: torch.randn(*s, dtype=torch.bfloat16) * 0.8)(D, 2 * Fh)), 'w_sp': _w(0.01 * (lambda *s: torch.randn(*s, dtype=torch.bfloat16) * 0.8)(S, S)), 'b_sp': _w(1.0 + 0.01 * (lambda *s: torch.randn(*s, dtype=torch.bfloat16) * 0.1)(S)), 'w_out': _w((lambda *s: torch.randn(*s, dtype=torch.bfloat16) * 0.1)(Fh, D))}
    _B_in = _B_setup()
    return {'A_q': _A_in['q'], 'A_k': _A_in['k'], 'A_v': _A_in['v'], 'A_shift_k': _A_in['shift_k'], 'A_ssm_k': _A_in['ssm_k'], 'A_ssm_D': _A_in['ssm_D'], 'B_x': _B_in['x'], 'B_w_in': _B_in['w_in'], 'B_w_sp': _B_in['w_sp'], 'B_b_sp': _B_in['b_sp'], 'B_w_out': _B_in['w_out']}

def reference(A_q, A_k, A_v, A_shift_k, A_ssm_k, A_ssm_D, B_x, B_w_in, B_w_sp, B_b_sp, B_w_out):

    def _A_ref(q, k, v, shift_k, ssm_k, ssm_D):
        B, S, D = q.shape
        ks = shift_k.shape[-1]
        k_pad = _pad(k, ((0, 0), (ks - 1, 0), (0, 0)))
        k_shift = torch.zeros_like(k)
        for t in range(ks):
            k_shift = k_shift + k_pad[:, t:t + S, :] * shift_k[:, ks - 1 - t][None, None, :]
        kv = k_shift * v
        L = 2 * S
        kv_pad = _pad(kv, ((0, 0), (0, S), (0, 0)))
        kf_pad = _pad(ssm_k, ((0, 0), (0, S)))
        kv_f = (lambda x, axes=(-2, -1): torch.fft.rfft2(x.float(), dim=axes))(kv_pad[:, None, :, :], axes=(1, 2))
        kf_f = (lambda x, axes=(-2, -1): torch.fft.rfft2(x.float(), dim=axes))(kf_pad[:, None, :], axes=(1, 2))
        kf_f = (lambda x, *d: x.permute(*d))(kf_f, 1, 2, 0)
        y_f = kv_f * kf_f[None, :, :, :]
        y = (lambda x, s, axes=(-2, -1): torch.fft.irfft2(x, s=s, dim=axes).to(torch.bfloat16))(y_f, (1, L), axes=(1, 2))[:, 0, :S, :]
        y = y + kv * ssm_D[None, None, :]
        return q * y

    def _B_ref(x, w_in, w_sp, b_sp, w_out):
        B, S, D = x.shape
        F = w_in.shape[-1]
        Fh = F // 2
        z = _gelu(torch.einsum('bsd,df->bsf', x, w_in))
        z1 = z[..., :Fh].clone()
        z2 = _layernorm(z[..., Fh:], axis=-1)
        g = torch.einsum('ts,bsf->btf', w_sp, z2) + b_sp[None, :, None]
        return torch.einsum('bsf,fd->bsd', z1 * g, w_out)
    x = A_q
    xn = _layernorm(x, axis=-1)
    s = _A_ref(xn, A_k, A_v, A_shift_k, A_ssm_k, A_ssm_D)
    g = _silu(_B_ref(xn, B_w_in, B_w_sp, B_b_sp, B_w_out))
    return x + s * g
```

```asm
; @launch grid=(256,1,1) block=(512,1,1) lds=163840
.amdgcn_target "amdgcn-amd-amdhsa--gfx950"
.text
.globl recurrent_scan__ssm_conv_h3__mixer_gmlp__prompt_kernel
.p2align 8
.type recurrent_scan__ssm_conv_h3__mixer_gmlp__prompt_kernel,@function
recurrent_scan__ssm_conv_h3__mixer_gmlp__prompt_kernel:
    s_cmp_ge_u32 s2, 256
    s_cbranch_scc1 F_end
    s_load_dwordx4 s[8:11], s[0:1], 96
    v_lshrrev_b32 v1, 6, v0
    s_nop 0
    v_readfirstlane_b32 s24, v1
    v_and_b32 v1, 63, v0
    s_and_b32 s28, s2, 7
    s_lshr_b32 s29, s2, 3
    s_cmp_ge_u32 s2, 224
    s_cbranch_scc1 F_pf
    s_cmp_ge_u32 s24, 4
    s_cbranch_scc1 F_H
    s_load_dwordx2 s[4:5], s[0:1], 0
    s_load_dwordx2 s[6:7], s[0:1], 56
    s_load_dwordx4 s[64:67], s[0:1], 64
    s_setprio 1
    s_mul_i32 s30, s29, 37
    s_lshr_b32 s30, s30, 8
    s_mul_i32 s31, s30, 7
    s_sub_u32 s31, s29, s31
    s_lshr_b32 s25, s28, 1
    s_lshl_b32 s25, s25, 2
    s_add_u32 s25, s25, s30
    s_and_b32 s26, s28, 1
    s_mul_i32 s26, s26, 7
    s_add_u32 s26, s26, s31
    v_lshrrev_b32 v11, 3, v1
    v_and_b32 v12, 7, v1
    v_lshrrev_b32 v13, 4, v1
    v_mul_u32_u24 v14, 896, v11
    v_xor_b32 v15, v12, v13
    v_lshl_add_u32 v2, v15, 4, v14
    v_xor_b32 v15, 4, v15
    v_lshl_add_u32 v3, v15, 4, v14
    v_add_u32 v3, 7168, v3
    v_mul_u32_u24 v14, 3584, v11
    v_and_b32 v15, 1, v13
    v_lshlrev_b32 v15, 2, v15
    v_xor_b32 v15, v12, v15
    v_lshl_add_u32 v4, v15, 4, v14
    v_add_u32 v9, 28672, v4
    s_lshl_b32 s34, s25, 2
    s_add_u32 s34, s34, s24
    s_mul_i32 s35, s34, 28672
    s_mul_i32 s36, s24, 57344
    s_lshl_b32 s37, s26, 7
    s_add_u32 s38, s36, s37
    s_add_u32 s37, s38, 1792
    s_lshl_b32 s39, s24, 12
    s_lshl_b32 s47, s24, 11
    s_lshl_b32 s27, s30, 1
    s_add_u32 s27, s27, s31
    s_sub_u32 s33, s27, 7
    s_cmp_ge_u32 s27, 7
    s_cselect_b32 s27, s33, s27
    s_lshl_b32 s92, s27, 7
    s_add_u32 s93, s92, 128
    s_cmp_eq_u32 s93, 896
    s_cselect_b32 s93, 0, s93
    s_add_u32 s94, s93, 128
    s_cmp_eq_u32 s94, 896
    s_cselect_b32 s94, 0, s94
    s_add_u32 s95, s94, 128
    s_cmp_eq_u32 s95, 896
    s_cselect_b32 s95, 0, s95
    s_add_u32 s96, s95, 128
    s_cmp_eq_u32 s96, 896
    s_cselect_b32 s96, 0, s96
    s_add_u32 s97, s96, 128
    s_cmp_eq_u32 s97, 896
    s_cselect_b32 s97, 0, s97
    s_add_u32 s98, s97, 128
    s_cmp_eq_u32 s98, 896
    s_cselect_b32 s98, 0, s98
    s_waitcnt lgkmcnt(0)
    s_mov_b32 s12, s4
    s_and_b32 s13, s5, 0xffff
    s_mov_b32 s14, 1835008
    s_mov_b32 s15, 0x20000
    s_mov_b32 s16, s6
    s_and_b32 s17, s7, 0xffff
    s_mov_b32 s18, 1605632
    s_mov_b32 s19, 0x20000
    s_add_u32 m0, s39, 0
    s_add_u32 s32, s35, s92
    buffer_load_dwordx4 v2, s[12:15], s32 offen lds
    s_add_u32 m0, s39, 1024
    s_nop 0
    buffer_load_dwordx4 v3, s[12:15], s32 offen lds
    s_add_u32 m0, s39, 2048
    s_add_u32 s32, s32, 14336
    buffer_load_dwordx4 v2, s[12:15], s32 offen lds
    s_add_u32 m0, s39, 3072
    s_nop 0
    buffer_load_dwordx4 v3, s[12:15], s32 offen lds
    s_add_u32 m0, s47, 114688
    s_mul_i32 s43, s92, 1792
    s_add_u32 s43, s43, s37
    buffer_load_dwordx4 v4, s[16:19], s43 offen lds
    s_add_u32 m0, s47, 115712
    s_nop 0
    buffer_load_dwordx4 v9, s[16:19], s43 offen lds
    s_add_u32 m0, s39, 16384
    s_add_u32 s32, s35, s93
    buffer_load_dwordx4 v2, s[12:15], s32 offen lds
    s_add_u32 m0, s39, 17408
    s_nop 0
    buffer_load_dwordx4 v3, s[12:15], s32 offen lds
    s_add_u32 m0, s39, 18432
    s_add_u32 s32, s32, 14336
    buffer_load_dwordx4 v2, s[12:15], s32 offen lds
    s_add_u32 m0, s39, 19456
    s_nop 0
    buffer_load_dwordx4 v3, s[12:15], s32 offen lds
    s_add_u32 m0, s47, 122880
    s_mul_i32 s43, s93, 1792
    s_add_u32 s43, s43, s37
    buffer_load_dwordx4 v4, s[16:19], s43 offen lds
    s_add_u32 m0, s47, 123904
    s_nop 0
    buffer_load_dwordx4 v9, s[16:19], s43 offen lds
    s_add_u32 m0, s39, 32768
    s_add_u32 s32, s35, s94
    buffer_load_dwordx4 v2, s[12:15], s32 offen lds
    s_add_u32 m0, s39, 33792
    s_nop 0
    buffer_load_dwordx4 v3, s[12:15], s32 offen lds
    s_add_u32 m0, s39, 34816
    s_add_u32 s32, s32, 14336
    buffer_load_dwordx4 v2, s[12:15], s32 offen lds
    s_add_u32 m0, s39, 35840
    s_nop 0
    buffer_load_dwordx4 v3, s[12:15], s32 offen lds
    s_add_u32 m0, s47, 131072
    s_mul_i32 s43, s94, 1792
    s_add_u32 s43, s43, s37
    buffer_load_dwordx4 v4, s[16:19], s43 offen lds
    s_add_u32 m0, s47, 132096
    s_nop 0
    buffer_load_dwordx4 v9, s[16:19], s43 offen lds
    s_mov_b32 s20, s10
    s_and_b32 s21, s11, 0xffff
    s_mov_b32 s22, 22544384
    s_mov_b32 s23, 0x20000
    v_and_b32 v11, 31, v1
    v_lshrrev_b32 v12, 5, v1
    v_bfe_u32 v13, v1, 1, 3
    v_xor_b32 v13, v13, v12
    v_lshlrev_b32 v14, 7, v11
    v_add_u32 v14, s39, v14
    v_lshl_add_u32 v5, v13, 4, v14
    s_lshl_b32 s32, s24, 5
    v_xor_b32 v5, s32, v5
    v_xor_b32 v6, 32, v5
    v_xor_b32 v7, 64, v5
    v_xor_b32 v8, 96, v5
    v_lshrrev_b32 v12, 5, v1
    v_bfe_u32 v13, v1, 2, 2
    v_lshl_add_u32 v14, v12, 3, v13
    v_lshlrev_b32 v14, 7, v14
    v_bfe_u32 v15, v1, 4, 1
    v_lshl_add_u32 v14, v15, 5, v14
    v_and_b32 v15, 3, v1
    v_lshl_add_u32 v14, v15, 3, v14
    v_bfe_u32 v15, v1, 3, 1
    v_lshl_add_u32 v14, v15, 6, v14
    v_add_u32 v124, s47, v14
    v_xor_b32 v125, 2048, v124
    v_xor_b32 v126, 4096, v124
    v_xor_b32 v127, 6144, v124
    v_xor_b32 v128, 64, v124
    v_xor_b32 v129, 64, v125
    v_xor_b32 v130, 64, v126
    v_xor_b32 v131, 64, v127
    v_add_u32 v132, 114688, v124
    v_add_u32 v133, 114688, v125
    v_add_u32 v134, 114688, v126
    v_add_u32 v135, 114688, v127
    v_add_u32 v136, 114688, v128
    v_add_u32 v137, 114688, v129
    v_add_u32 v138, 114688, v130
    v_add_u32 v139, 114688, v131
    v_mov_b32 v104, 0x3f803f80
    v_mov_b32 v105, 0x3f803f80
    s_mov_b32 s48, 0x3f803f80
    s_mov_b32 s52, 0xaaaaaaaa
    s_mov_b32 s53, 0xaaaaaaaa
    s_mov_b32 s54, 0xcccccccc
    s_mov_b32 s55, 0xcccccccc
    s_mov_b32 s40, 0
    s_mov_b32 s41, -1
    s_waitcnt vmcnt(12)
    s_barrier
    ds_read_b128 v[144:147], v5 offset:0
    ds_read_b64_tr_b16 v[80:81], v132 offset:0
    ds_read_b64_tr_b16 v[82:83], v132 offset:512
    ds_read_b64_tr_b16 v[84:85], v136 offset:0
    ds_read_b64_tr_b16 v[86:87], v136 offset:512
    ds_read_b128 v[148:151], v6 offset:0
    ds_read_b64_tr_b16 v[88:89], v133 offset:0
    ds_read_b64_tr_b16 v[90:91], v133 offset:512
    ds_read_b64_tr_b16 v[92:93], v137 offset:0
    ds_read_b64_tr_b16 v[94:95], v137 offset:512
    s_waitcnt lgkmcnt(5)
    v_mfma_f32_32x32x16_bf16 v[16:31], v[80:83], v[144:147], 0
    ds_read_b128 v[152:155], v7 offset:0
    ds_read_b64_tr_b16 v[96:97], v134 offset:0
    ds_read_b64_tr_b16 v[98:99], v134 offset:512
    ds_read_b64_tr_b16 v[100:101], v138 offset:0
    ds_read_b64_tr_b16 v[102:103], v138 offset:512
    v_mfma_f32_32x32x16_bf16 v[32:47], v[84:87], v[144:147], 0
    s_add_u32 m0, s39, 49152
    s_add_u32 s32, s35, s95
    buffer_load_dwordx4 v2, s[12:15], s32 offen lds
    s_add_u32 m0, s39, 50176
    s_nop 0
    buffer_load_dwordx4 v3, s[12:15], s32 offen lds
    v_mfma_f32_4x4x4_16b_bf16 v[108:111], v[104:105], v[144:145], 0
    v_mfma_f32_4x4x4_16b_bf16 v[112:115], v[144:145], v[144:145], 0
    v_mfma_f32_4x4x4_16b_bf16 v[116:119], v[104:105], v[80:81], 0
    v_mfma_f32_4x4x4_16b_bf16 v[120:123], v[104:105], v[84:85], 0
    v_mfma_f32_4x4x4_16b_bf16 v[108:111], v[104:105], v[146:147], v[108:111]
    v_mfma_f32_4x4x4_16b_bf16 v[112:115], v[146:147], v[146:147], v[112:115]
    v_mfma_f32_4x4x4_16b_bf16 v[116:119], v[104:105], v[82:83], v[116:119]
    v_mfma_f32_4x4x4_16b_bf16 v[120:123], v[104:105], v[86:87], v[120:123]
    s_waitcnt lgkmcnt(5)
    v_mfma_f32_32x32x16_bf16 v[16:31], v[88:91], v[148:151], v[16:31]
    ds_read_b128 v[156:159], v8 offset:0
    ds_read_b64_tr_b16 v[80:81], v135 offset:0
    ds_read_b64_tr_b16 v[82:83], v135 offset:512
    ds_read_b64_tr_b16 v[84:85], v139 offset:0
    ds_read_b64_tr_b16 v[86:87], v139 offset:512
    v_mfma_f32_32x32x16_bf16 v[32:47], v[92:95], v[148:151], v[32:47]
    s_add_u32 m0, s39, 51200
    s_add_u32 s32, s32, 14336
    buffer_load_dwordx4 v2, s[12:15], s32 offen lds
    s_add_u32 m0, s39, 52224
    s_nop 0
    buffer_load_dwordx4 v3, s[12:15], s32 offen lds
    v_mfma_f32_4x4x4_16b_bf16 v[108:111], v[104:105], v[148:149], v[108:111]
    v_mfma_f32_4x4x4_16b_bf16 v[112:115], v[148:149], v[148:149], v[112:115]
    s_nop 0
    v_mfma_f32_4x4x4_16b_bf16 v[108:111], v[104:105], v[150:151], v[108:111]
    v_mfma_f32_4x4x4_16b_bf16 v[112:115], v[150:151], v[150:151], v[112:115]
    s_waitcnt lgkmcnt(5)
    v_mfma_f32_32x32x16_bf16 v[16:31], v[96:99], v[152:155], v[16:31]
    s_waitcnt vmcnt(10)
    s_barrier
    ds_read_b128 v[160:163], v5 offset:16384
    ds_read_b64_tr_b16 v[88:89], v132 offset:8192
    ds_read_b64_tr_b16 v[90:91], v132 offset:8704
    ds_read_b64_tr_b16 v[92:93], v136 offset:8192
    ds_read_b64_tr_b16 v[94:95], v136 offset:8704
    v_mfma_f32_32x32x16_bf16 v[32:47], v[100:103], v[152:155], v[32:47]
    s_add_u32 m0, s47, 139264
    s_mul_i32 s43, s95, 1792
    s_add_u32 s43, s43, s37
    buffer_load_dwordx4 v4, s[16:19], s43 offen lds
    s_add_u32 m0, s47, 140288
    s_nop 0
    buffer_load_dwordx4 v9, s[16:19], s43 offen lds
    v_mfma_f32_4x4x4_16b_bf16 v[108:111], v[104:105], v[152:153], v[108:111]
    v_mfma_f32_4x4x4_16b_bf16 v[112:115], v[152:153], v[152:153], v[112:115]
    s_nop 0
    v_mfma_f32_4x4x4_16b_bf16 v[108:111], v[104:105], v[154:155], v[108:111]
    v_mfma_f32_4x4x4_16b_bf16 v[112:115], v[154:155], v[154:155], v[112:115]
    s_waitcnt lgkmcnt(5)
    v_mfma_f32_32x32x16_bf16 v[16:31], v[80:83], v[156:159], v[16:31]
    ds_read_b128 v[164:167], v6 offset:16384
    ds_read_b64_tr_b16 v[96:97], v133 offset:8192
    ds_read_b64_tr_b16 v[98:99], v133 offset:8704
    ds_read_b64_tr_b16 v[100:101], v137 offset:8192
    ds_read_b64_tr_b16 v[102:103], v137 offset:8704
    v_mfma_f32_32x32x16_bf16 v[32:47], v[84:87], v[156:159], v[32:47]
    s_add_u32 m0, s39, 65536
    s_add_u32 s32, s35, s96
    buffer_load_dwordx4 v2, s[12:15], s32 offen lds
    s_add_u32 m0, s39, 66560
    s_nop 0
    buffer_load_dwordx4 v3, s[12:15], s32 offen lds
    v_mfma_f32_4x4x4_16b_bf16 v[108:111], v[104:105], v[156:157], v[108:111]
    v_mfma_f32_4x4x4_16b_bf16 v[112:115], v[156:157], v[156:157], v[112:115]
    s_nop 0
    v_mfma_f32_4x4x4_16b_bf16 v[108:111], v[104:105], v[158:159], v[108:111]
    v_mfma_f32_4x4x4_16b_bf16 v[112:115], v[158:159], v[158:159], v[112:115]
    s_waitcnt lgkmcnt(5)
    v_mfma_f32_32x32x16_bf16 v[16:31], v[88:91], v[160:163], v[16:31]
    ds_read_b128 v[168:171], v7 offset:16384
    ds_read_b64_tr_b16 v[80:81], v134 offset:8192
    ds_read_b64_tr_b16 v[82:83], v134 offset:8704
    ds_read_b64_tr_b16 v[84:85], v138 offset:8192
    ds_read_b64_tr_b16 v[86:87], v138 offset:8704
    v_mfma_f32_32x32x16_bf16 v[32:47], v[92:95], v[160:163], v[32:47]
    s_add_u32 m0, s39, 67584
    s_add_u32 s32, s32, 14336
    buffer_load_dwordx4 v2, s[12:15], s32 offen lds
    s_add_u32 m0, s39, 68608
    s_nop 0
    buffer_load_dwordx4 v3, s[12:15], s32 offen lds
    v_mfma_f32_4x4x4_16b_bf16 v[108:111], v[104:105], v[160:161], v[108:111]
    v_mfma_f32_4x4x4_16b_bf16 v[112:115], v[160:161], v[160:161], v[112:115]
    v_mfma_f32_4x4x4_16b_bf16 v[116:119], v[104:105], v[88:89], v[116:119]
    v_mfma_f32_4x4x4_16b_bf16 v[120:123], v[104:105], v[92:93], v[120:123]
    v_mfma_f32_4x4x4_16b_bf16 v[108:111], v[104:105], v[162:163], v[108:111]
    v_mfma_f32_4x4x4_16b_bf16 v[112:115], v[162:163], v[162:163], v[112:115]
    v_mfma_f32_4x4x4_16b_bf16 v[116:119], v[104:105], v[90:91], v[116:119]
    v_mfma_f32_4x4x4_16b_bf16 v[120:123], v[104:105], v[94:95], v[120:123]
    s_waitcnt lgkmcnt(5)
    v_mfma_f32_32x32x16_bf16 v[16:31], v[96:99], v[164:167], v[16:31]
    ds_read_b128 v[172:175], v8 offset:16384
    ds_read_b64_tr_b16 v[88:89], v135 offset:8192
    ds_read_b64_tr_b16 v[90:91], v135 offset:8704
    ds_read_b64_tr_b16 v[92:93], v139 offset:8192
    ds_read_b64_tr_b16 v[94:95], v139 offset:8704
    v_mfma_f32_32x32x16_bf16 v[32:47], v[100:103], v[164:167], v[32:47]
    s_add_u32 m0, s47, 147456
    s_mul_i32 s43, s96, 1792
    s_add_u32 s43, s43, s37
    buffer_load_dwordx4 v4, s[16:19], s43 offen lds
    s_add_u32 m0, s47, 148480
    s_nop 0
    buffer_load_dwordx4 v9, s[16:19], s43 offen lds
    v_mfma_f32_4x4x4_16b_bf16 v[108:111], v[104:105], v[164:165], v[108:111]
    v_mfma_f32_4x4x4_16b_bf16 v[112:115], v[164:165], v[164:165], v[112:115]
    s_nop 0
    v_mfma_f32_4x4x4_16b_bf16 v[108:111], v[104:105], v[166:167], v[108:111]
    v_mfma_f32_4x4x4_16b_bf16 v[112:115], v[166:167], v[166:167], v[112:115]
    s_waitcnt lgkmcnt(5)
    v_mfma_f32_32x32x16_bf16 v[16:31], v[80:83], v[168:171], v[16:31]
    s_waitcnt vmcnt(12)
    s_barrier
    ds_read_b128 v[176:179], v5 offset:32768
    ds_read_b64_tr_b16 v[96:97], v132 offset:16384
    ds_read_b64_tr_b16 v[98:99], v132 offset:16896
    ds_read_b64_tr_b16 v[100:101], v136 offset:16384
    ds_read_b64_tr_b16 v[102:103], v136 offset:16896
    v_mfma_f32_32x32x16_bf16 v[32:47], v[84:87], v[168:171], v[32:47]
    s_add_u32 m0, s39, 81920
    s_add_u32 s32, s35, s97
    buffer_load_dwordx4 v2, s[12:15], s32 offen lds
    s_add_u32 m0, s39, 82944
    s_nop 0
    buffer_load_dwordx4 v3, s[12:15], s32 offen lds
    v_mfma_f32_4x4x4_16b_bf16 v[108:111], v[104:105], v[168:169], v[108:111]
    v_mfma_f32_4x4x4_16b_bf16 v[112:115], v[168:169], v[168:169], v[112:115]
    s_nop 0
    v_mfma_f32_4x4x4_16b_bf16 v[108:111], v[104:105], v[170:171], v[108:111]
    v_mfma_f32_4x4x4_16b_bf16 v[112:115], v[170:171], v[170:171], v[112:115]
    s_waitcnt lgkmcnt(5)
    v_mfma_f32_32x32x16_bf16 v[16:31], v[88:91], v[172:175], v[16:31]
    ds_read_b128 v[180:183], v6 offset:32768
    ds_read_b64_tr_b16 v[80:81], v133 offset:16384
    ds_read_b64_tr_b16 v[82:83], v133 offset:16896
    ds_read_b64_tr_b16 v[84:85], v137 offset:16384
    ds_read_b64_tr_b16 v[86:87], v137 offset:16896
    v_mfma_f32_32x32x16_bf16 v[32:47], v[92:95], v[172:175], v[32:47]
    s_add_u32 m0, s39, 83968
    s_add_u32 s32, s32, 14336
    buffer_load_dwordx4 v2, s[12:15], s32 offen lds
    s_add_u32 m0, s39, 84992
    s_nop 0
    buffer_load_dwordx4 v3, s[12:15], s32 offen lds
    v_mfma_f32_4x4x4_16b_bf16 v[108:111], v[104:105], v[172:173], v[108:111]
    v_mfma_f32_4x4x4_16b_bf16 v[112:115], v[172:173], v[172:173], v[112:115]
    s_nop 0
    v_mfma_f32_4x4x4_16b_bf16 v[108:111], v[104:105], v[174:175], v[108:111]
    v_mfma_f32_4x4x4_16b_bf16 v[112:115], v[174:175], v[174:175], v[112:115]
    s_waitcnt lgkmcnt(5)
    v_mfma_f32_32x32x16_bf16 v[16:31], v[96:99], v[176:179], v[16:31]
    ds_read_b128 v[184:187], v7 offset:32768
    ds_read_b64_tr_b16 v[88:89], v134 offset:16384
    ds_read_b64_tr_b16 v[90:91], v134 offset:16896
    ds_read_b64_tr_b16 v[92:93], v138 offset:16384
    ds_read_b64_tr_b16 v[94:95], v138 offset:16896
    v_mfma_f32_32x32x16_bf16 v[32:47], v[100:103], v[176:179], v[32:47]
    s_add_u32 m0, s47, 0
    s_mul_i32 s43, s97, 1792
    s_add_u32 s43, s43, s37
    buffer_load_dwordx4 v4, s[16:19], s43 offen lds
    s_add_u32 m0, s47, 1024
    s_nop 0
    buffer_load_dwordx4 v9, s[16:19], s43 offen lds
    v_mfma_f32_4x4x4_16b_bf16 v[108:111], v[104:105], v[176:177], v[108:111]
    v_mfma_f32_4x4x4_16b_bf16 v[112:115], v[176:177], v[176:177], v[112:115]
    v_mfma_f32_4x4x4_16b_bf16 v[116:119], v[104:105], v[96:97], v[116:119]
    v_mfma_f32_4x4x4_16b_bf16 v[120:123], v[104:105], v[100:101], v[120:123]
    v_mfma_f32_4x4x4_16b_bf16 v[108:111], v[104:105], v[178:179], v[108:111]
    v_mfma_f32_4x4x4_16b_bf16 v[112:115], v[178:179], v[178:179], v[112:115]
    v_mfma_f32_4x4x4_16b_bf16 v[116:119], v[104:105], v[98:99], v[116:119]
    v_mfma_f32_4x4x4_16b_bf16 v[120:123], v[104:105], v[102:103], v[120:123]
    s_waitcnt lgkmcnt(5)
    v_mfma_f32_32x32x16_bf16 v[16:31], v[80:83], v[180:183], v[16:31]
    ds_read_b128 v[188:191], v8 offset:32768
    ds_read_b64_tr_b16 v[96:97], v135 offset:16384
    ds_read_b64_tr_b16 v[98:99], v135 offset:16896
    ds_read_b64_tr_b16 v[100:101], v139 offset:16384
    ds_read_b64_tr_b16 v[102:103], v139 offset:16896
    v_mfma_f32_32x32x16_bf16 v[32:47], v[84:87], v[180:183], v[32:47]
    s_add_u32 m0, s39, 98304
    s_add_u32 s32, s35, s98
    buffer_load_dwordx4 v2, s[12:15], s32 offen lds
    s_add_u32 m0, s39, 99328
    s_nop 0
    buffer_load_dwordx4 v3, s[12:15], s32 offen lds
    v_mfma_f32_4x4x4_16b_bf16 v[108:111], v[104:105], v[180:181], v[108:111]
    v_mfma_f32_4x4x4_16b_bf16 v[112:115], v[180:181], v[180:181], v[112:115]
    s_nop 0
    v_mfma_f32_4x4x4_16b_bf16 v[108:111], v[104:105], v[182:183], v[108:111]
    v_mfma_f32_4x4x4_16b_bf16 v[112:115], v[182:183], v[182:183], v[112:115]
    s_waitcnt lgkmcnt(5)
    v_mfma_f32_32x32x16_bf16 v[16:31], v[88:91], v[184:187], v[16:31]
    s_waitcnt vmcnt(14)
    s_barrier
    ds_read_b128 v[192:195], v5 offset:49152
    ds_read_b64_tr_b16 v[80:81], v132 offset:24576
    ds_read_b64_tr_b16 v[82:83], v132 offset:25088
    ds_read_b64_tr_b16 v[84:85], v136 offset:24576
    ds_read_b64_tr_b16 v[86:87], v136 offset:25088
    v_mfma_f32_32x32x16_bf16 v[32:47], v[92:95], v[184:187], v[32:47]
    s_add_u32 m0, s39, 100352
    s_add_u32 s32, s32, 14336
    buffer_load_dwordx4 v2, s[12:15], s32 offen lds
    s_add_u32 m0, s39, 101376
    s_nop 0
    buffer_load_dwordx4 v3, s[12:15], s32 offen lds
    v_mfma_f32_4x4x4_16b_bf16 v[108:111], v[104:105], v[184:185], v[108:111]
    v_mfma_f32_4x4x4_16b_bf16 v[112:115], v[184:185], v[184:185], v[112:115]
    s_nop 0
    v_mfma_f32_4x4x4_16b_bf16 v[108:111], v[104:105], v[186:187], v[108:111]
    v_mfma_f32_4x4x4_16b_bf16 v[112:115], v[186:187], v[186:187], v[112:115]
    s_waitcnt lgkmcnt(5)
    v_mfma_f32_32x32x16_bf16 v[16:31], v[96:99], v[188:191], v[16:31]
    ds_read_b128 v[196:199], v6 offset:49152
    ds_read_b64_tr_b16 v[88:89], v133 offset:24576
    ds_read_b64_tr_b16 v[90:91], v133 offset:25088
    ds_read_b64_tr_b16 v[92:93], v137 offset:24576
    ds_read_b64_tr_b16 v[94:95], v137 offset:25088
    v_mfma_f32_32x32x16_bf16 v[32:47], v[100:103], v[188:191], v[32:47]
    s_add_u32 m0, s47, 8192
    s_mul_i32 s43, s98, 1792
    s_add_u32 s43, s43, s37
    buffer_load_dwordx4 v4, s[16:19], s43 offen lds
    s_add_u32 m0, s47, 9216
    s_nop 0
    buffer_load_dwordx4 v9, s[16:19], s43 offen lds
    v_mfma_f32_4x4x4_16b_bf16 v[108:111], v[104:105], v[188:189], v[108:111]
    v_mfma_f32_4x4x4_16b_bf16 v[112:115], v[188:189], v[188:189], v[112:115]
    s_nop 0
    v_mfma_f32_4x4x4_16b_bf16 v[108:111], v[104:105], v[190:191], v[108:111]
    v_mfma_f32_4x4x4_16b_bf16 v[112:115], v[190:191], v[190:191], v[112:115]
    s_waitcnt lgkmcnt(5)
    v_mfma_f32_32x32x16_bf16 v[16:31], v[80:83], v[192:195], v[16:31]
    ds_read_b128 v[200:203], v7 offset:49152
    ds_read_b64_tr_b16 v[96:97], v134 offset:24576
    ds_read_b64_tr_b16 v[98:99], v134 offset:25088
    ds_read_b64_tr_b16 v[100:101], v138 offset:24576
    ds_read_b64_tr_b16 v[102:103], v138 offset:25088
    v_mfma_f32_32x32x16_bf16 v[32:47], v[84:87], v[192:195], v[32:47]
    s_add_u32 m0, s47, 114688
    s_mul_i32 s43, s92, 1792
    s_add_u32 s43, s43, s38
    buffer_load_dwordx4 v4, s[16:19], s43 offen lds
    s_add_u32 m0, s47, 115712
    s_nop 0
    buffer_load_dwordx4 v9, s[16:19], s43 offen lds
    v_mfma_f32_4x4x4_16b_bf16 v[108:111], v[104:105], v[192:193], v[108:111]
    v_mfma_f32_4x4x4_16b_bf16 v[112:115], v[192:193], v[192:193], v[112:115]
    v_mfma_f32_4x4x4_16b_bf16 v[116:119], v[104:105], v[80:81], v[116:119]
    v_mfma_f32_4x4x4_16b_bf16 v[120:123], v[104:105], v[84:85], v[120:123]
    v_mfma_f32_4x4x4_16b_bf16 v[108:111], v[104:105], v[194:195], v[108:111]
    v_mfma_f32_4x4x4_16b_bf16 v[112:115], v[194:195], v[194:195], v[112:115]
    v_mfma_f32_4x4x4_16b_bf16 v[116:119], v[104:105], v[82:83], v[116:119]
    v_mfma_f32_4x4x4_16b_bf16 v[120:123], v[104:105], v[86:87], v[120:123]
    s_waitcnt lgkmcnt(5)
    v_mfma_f32_32x32x16_bf16 v[16:31], v[88:91], v[196:199], v[16:31]
    ds_read_b128 v[204:207], v8 offset:49152
    ds_read_b64_tr_b16 v[80:81], v135 offset:24576
    ds_read_b64_tr_b16 v[82:83], v135 offset:25088
    ds_read_b64_tr_b16 v[84:85], v139 offset:24576
    ds_read_b64_tr_b16 v[86:87], v139 offset:25088
    v_mfma_f32_32x32x16_bf16 v[32:47], v[92:95], v[196:199], v[32:47]
    s_add_u32 m0, s47, 16384
    s_mul_i32 s43, s93, 1792
    s_add_u32 s43, s43, s38
    buffer_load_dwordx4 v4, s[16:19], s43 offen lds
    s_add_u32 m0, s47, 17408
    s_nop 0
    buffer_load_dwordx4 v9, s[16:19], s43 offen lds
    v_mfma_f32_4x4x4_16b_bf16 v[108:111], v[104:105], v[196:197], v[108:111]
    v_mfma_f32_4x4x4_16b_bf16 v[112:115], v[196:197], v[196:197], v[112:115]
    s_nop 0
    v_mfma_f32_4x4x4_16b_bf16 v[108:111], v[104:105], v[198:199], v[108:111]
    v_mfma_f32_4x4x4_16b_bf16 v[112:115], v[198:199], v[198:199], v[112:115]
    s_waitcnt lgkmcnt(5)
    v_mfma_f32_32x32x16_bf16 v[16:31], v[96:99], v[200:203], v[16:31]
    s_waitcnt vmcnt(16)
    s_barrier
    v_add_u32 v5, 0x10000, v5
    v_add_u32 v6, 0x10000, v6
    v_add_u32 v7, 0x10000, v7
    v_add_u32 v8, 0x10000, v8
    ds_read_b128 v[208:211], v5 offset:0
    ds_read_b64_tr_b16 v[88:89], v132 offset:32768
    ds_read_b64_tr_b16 v[90:91], v132 offset:33280
    ds_read_b64_tr_b16 v[92:93], v136 offset:32768
    ds_read_b64_tr_b16 v[94:95], v136 offset:33280
    v_mfma_f32_32x32x16_bf16 v[32:47], v[100:103], v[200:203], v[32:47]
    s_add_u32 m0, s47, 24576
    s_mul_i32 s43, s94, 1792
    s_add_u32 s43, s43, s38
    buffer_load_dwordx4 v4, s[16:19], s43 offen lds
    s_add_u32 m0, s47, 25600
    s_nop 0
    buffer_load_dwordx4 v9, s[16:19], s43 offen lds
    v_mfma_f32_4x4x4_16b_bf16 v[108:111], v[104:105], v[200:201], v[108:111]
    v_mfma_f32_4x4x4_16b_bf16 v[112:115], v[200:201], v[200:201], v[112:115]
    s_nop 0
    v_mfma_f32_4x4x4_16b_bf16 v[108:111], v[104:105], v[202:203], v[108:111]
    v_mfma_f32_4x4x4_16b_bf16 v[112:115], v[202:203], v[202:203], v[112:115]
    s_waitcnt lgkmcnt(5)
    v_mfma_f32_32x32x16_bf16 v[16:31], v[80:83], v[204:207], v[16:31]
    ds_read_b128 v[212:215], v6 offset:0
    ds_read_b64_tr_b16 v[96:97], v133 offset:32768
    ds_read_b64_tr_b16 v[98:99], v133 offset:33280
    ds_read_b64_tr_b16 v[100:101], v137 offset:32768
    ds_read_b64_tr_b16 v[102:103], v137 offset:33280
    v_mfma_f32_32x32x16_bf16 v[32:47], v[84:87], v[204:207], v[32:47]
    s_add_u32 m0, s47, 122880
    s_mul_i32 s43, s95, 1792
    s_add_u32 s43, s43, s38
    buffer_load_dwordx4 v4, s[16:19], s43 offen lds
    s_add_u32 m0, s47, 123904
    s_nop 0
    buffer_load_dwordx4 v9, s[16:19], s43 offen lds
    v_mfma_f32_4x4x4_16b_bf16 v[108:111], v[104:105], v[204:205], v[108:111]
    v_mfma_f32_4x4x4_16b_bf16 v[112:115], v[204:205], v[204:205], v[112:115]
    s_nop 0
    v_mfma_f32_4x4x4_16b_bf16 v[108:111], v[104:105], v[206:207], v[108:111]
    v_mfma_f32_4x4x4_16b_bf16 v[112:115], v[206:207], v[206:207], v[112:115]
    s_waitcnt lgkmcnt(5)
    v_mfma_f32_32x32x16_bf16 v[16:31], v[88:91], v[208:211], v[16:31]
    ds_read_b128 v[216:219], v7 offset:0
    ds_read_b64_tr_b16 v[80:81], v134 offset:32768
    ds_read_b64_tr_b16 v[82:83], v134 offset:33280
    ds_read_b64_tr_b16 v[84:85], v138 offset:32768
    ds_read_b64_tr_b16 v[86:87], v138 offset:33280
    v_mfma_f32_32x32x16_bf16 v[32:47], v[92:95], v[208:211], v[32:47]
    s_add_u32 m0, s47, 32768
    s_mul_i32 s43, s96, 1792
    s_add_u32 s43, s43, s38
    buffer_load_dwordx4 v4, s[16:19], s43 offen lds
    s_add_u32 m0, s47, 33792
    s_nop 0
    buffer_load_dwordx4 v9, s[16:19], s43 offen lds
    v_mfma_f32_4x4x4_16b_bf16 v[108:111], v[104:105], v[208:209], v[108:111]
    v_mfma_f32_4x4x4_16b_bf16 v[112:115], v[208:209], v[208:209], v[112:115]
    v_mfma_f32_4x4x4_16b_bf16 v[116:119], v[104:105], v[88:89], v[116:119]
    v_mfma_f32_4x4x4_16b_bf16 v[120:123], v[104:105], v[92:93], v[120:123]
    v_mfma_f32_4x4x4_16b_bf16 v[108:111], v[104:105], v[210:211], v[108:111]
    v_mfma_f32_4x4x4_16b_bf16 v[112:115], v[210:211], v[210:211], v[112:115]
    v_mfma_f32_4x4x4_16b_bf16 v[116:119], v[104:105], v[90:91], v[116:119]
    v_mfma_f32_4x4x4_16b_bf16 v[120:123], v[104:105], v[94:95], v[120:123]
    s_waitcnt lgkmcnt(5)
    v_mfma_f32_32x32x16_bf16 v[16:31], v[96:99], v[212:215], v[16:31]
    ds_read_b128 v[220:223], v8 offset:0
    ds_read_b64_tr_b16 v[88:89], v135 offset:32768
    ds_read_b64_tr_b16 v[90:91], v135 offset:33280
    ds_read_b64_tr_b16 v[92:93], v139 offset:32768
    ds_read_b64_tr_b16 v[94:95], v139 offset:33280
    v_mfma_f32_32x32x16_bf16 v[32:47], v[100:103], v[212:215], v[32:47]
    s_add_u32 m0, s47, 40960
    s_mul_i32 s43, s97, 1792
    s_add_u32 s43, s43, s38
    buffer_load_dwordx4 v4, s[16:19], s43 offen lds
    s_add_u32 m0, s47, 41984
    s_nop 0
    buffer_load_dwordx4 v9, s[16:19], s43 offen lds
    v_mfma_f32_4x4x4_16b_bf16 v[108:111], v[104:105], v[212:213], v[108:111]
    v_mfma_f32_4x4x4_16b_bf16 v[112:115], v[212:213], v[212:213], v[112:115]
    s_nop 0
    v_mfma_f32_4x4x4_16b_bf16 v[108:111], v[104:105], v[214:215], v[108:111]
    v_mfma_f32_4x4x4_16b_bf16 v[112:115], v[214:215], v[214:215], v[112:115]
    s_waitcnt lgkmcnt(5)
    v_mfma_f32_32x32x16_bf16 v[16:31], v[80:83], v[216:219], v[16:31]
    s_waitcnt vmcnt(18)
    s_barrier
    ds_read_b128 v[224:227], v5 offset:16384
    ds_read_b64_tr_b16 v[96:97], v124 offset:0
    ds_read_b64_tr_b16 v[98:99], v124 offset:512
    ds_read_b64_tr_b16 v[100:101], v128 offset:0
    ds_read_b64_tr_b16 v[102:103], v128 offset:512
    v_mfma_f32_32x32x16_bf16 v[32:47], v[84:87], v[216:219], v[32:47]
    s_add_u32 m0, s47, 131072
    s_mul_i32 s43, s98, 1792
    s_add_u32 s43, s43, s38
    buffer_load_dwordx4 v4, s[16:19], s43 offen lds
    s_add_u32 m0, s47, 132096
    s_nop 0
    buffer_load_dwordx4 v9, s[16:19], s43 offen lds
    v_mfma_f32_4x4x4_16b_bf16 v[108:111], v[104:105], v[216:217], v[108:111]
    v_mfma_f32_4x4x4_16b_bf16 v[112:115], v[216:217], v[216:217], v[112:115]
    s_nop 0
    v_mfma_f32_4x4x4_16b_bf16 v[108:111], v[104:105], v[218:219], v[108:111]
    v_mfma_f32_4x4x4_16b_bf16 v[112:115], v[218:219], v[218:219], v[112:115]
    s_waitcnt lgkmcnt(5)
    v_mfma_f32_32x32x16_bf16 v[16:31], v[88:91], v[220:223], v[16:31]
    ds_read_b128 v[228:231], v6 offset:16384
    ds_read_b64_tr_b16 v[80:81], v125 offset:0
    ds_read_b64_tr_b16 v[82:83], v125 offset:512
    ds_read_b64_tr_b16 v[84:85], v129 offset:0
    ds_read_b64_tr_b16 v[86:87], v129 offset:512
    v_mfma_f32_32x32x16_bf16 v[32:47], v[92:95], v[220:223], v[32:47]
    v_mfma_f32_4x4x4_16b_bf16 v[108:111], v[104:105], v[220:221], v[108:111]
    v_mfma_f32_4x4x4_16b_bf16 v[112:115], v[220:221], v[220:221], v[112:115]
    s_nop 0
    v_mfma_f32_4x4x4_16b_bf16 v[108:111], v[104:105], v[222:223], v[108:111]
    v_mfma_f32_4x4x4_16b_bf16 v[112:115], v[222:223], v[222:223], v[112:115]
    v_mov_b32 v11, 0
    global_load_dwordx2 v[106:107], v11, s[8:9] sc1
    s_waitcnt lgkmcnt(5)
    v_mfma_f32_32x32x16_bf16 v[16:31], v[96:99], v[224:227], v[16:31]
    ds_read_b128 v[232:235], v7 offset:16384
    ds_read_b64_tr_b16 v[88:89], v126 offset:0
    ds_read_b64_tr_b16 v[90:91], v126 offset:512
    ds_read_b64_tr_b16 v[92:93], v130 offset:0
    ds_read_b64_tr_b16 v[94:95], v130 offset:512
    v_mfma_f32_32x32x16_bf16 v[32:47], v[100:103], v[224:227], v[32:47]
    v_mfma_f32_4x4x4_16b_bf16 v[108:111], v[104:105], v[224:225], v[108:111]
    v_mfma_f32_4x4x4_16b_bf16 v[112:115], v[224:225], v[224:225], v[112:115]
    v_mfma_f32_4x4x4_16b_bf16 v[116:119], v[104:105], v[96:97], v[116:119]
    v_mfma_f32_4x4x4_16b_bf16 v[120:123], v[104:105], v[100:101], v[120:123]
    v_mfma_f32_4x4x4_16b_bf16 v[108:111], v[104:105], v[226:227], v[108:111]
    v_mfma_f32_4x4x4_16b_bf16 v[112:115], v[226:227], v[226:227], v[112:115]
    v_mfma_f32_4x4x4_16b_bf16 v[116:119], v[104:105], v[98:99], v[116:119]
    v_mfma_f32_4x4x4_16b_bf16 v[120:123], v[104:105], v[102:103], v[120:123]
    s_waitcnt lgkmcnt(5)
    v_mfma_f32_32x32x16_bf16 v[16:31], v[80:83], v[228:231], v[16:31]
    ds_read_b128 v[236:239], v8 offset:16384
    ds_read_b64_tr_b16 v[96:97], v127 offset:0
    ds_read_b64_tr_b16 v[98:99], v127 offset:512
    ds_read_b64_tr_b16 v[100:101], v131 offset:0
    ds_read_b64_tr_b16 v[102:103], v131 offset:512
    v_mfma_f32_32x32x16_bf16 v[32:47], v[84:87], v[228:231], v[32:47]
    v_mfma_f32_4x4x4_16b_bf16 v[108:111], v[104:105], v[228:229], v[108:111]
    v_mfma_f32_4x4x4_16b_bf16 v[112:115], v[228:229], v[228:229], v[112:115]
    s_nop 0
    v_mfma_f32_4x4x4_16b_bf16 v[108:111], v[104:105], v[230:231], v[108:111]
    v_mfma_f32_4x4x4_16b_bf16 v[112:115], v[230:231], v[230:231], v[112:115]
    s_waitcnt lgkmcnt(5)
    v_mfma_f32_32x32x16_bf16 v[16:31], v[88:91], v[232:235], v[16:31]
    s_waitcnt vmcnt(15)
    s_barrier
    ds_read_b128 v[240:243], v5 offset:32768
    ds_read_b64_tr_b16 v[80:81], v124 offset:8192
    ds_read_b64_tr_b16 v[82:83], v124 offset:8704
    ds_read_b64_tr_b16 v[84:85], v128 offset:8192
    ds_read_b64_tr_b16 v[86:87], v128 offset:8704
    ds_read_b128 v[244:247], v6 offset:32768
    v_mfma_f32_32x32x16_bf16 v[32:47], v[92:95], v[232:235], v[32:47]
    v_mfma_f32_4x4x4_16b_bf16 v[108:111], v[104:105], v[232:233], v[108:111]
    v_mfma_f32_4x4x4_16b_bf16 v[112:115], v[232:233], v[232:233], v[112:115]
    s_nop 0
    v_mfma_f32_4x4x4_16b_bf16 v[108:111], v[104:105], v[234:235], v[108:111]
    v_mfma_f32_4x4x4_16b_bf16 v[112:115], v[234:235], v[234:235], v[112:115]
    s_waitcnt lgkmcnt(6)
    v_mfma_f32_32x32x16_bf16 v[16:31], v[96:99], v[236:239], v[16:31]
    ds_read_b128 v[248:251], v7 offset:32768
    ds_read_b128 v[252:255], v8 offset:32768
    ds_read_b64_tr_b16 v[88:89], v125 offset:8192
    ds_read_b64_tr_b16 v[90:91], v125 offset:8704
    ds_read_b64_tr_b16 v[92:93], v129 offset:8192
    ds_read_b64_tr_b16 v[94:95], v129 offset:8704
    v_mfma_f32_32x32x16_bf16 v[32:47], v[100:103], v[236:239], v[32:47]
    v_mfma_f32_4x4x4_16b_bf16 v[108:111], v[104:105], v[236:237], v[108:111]
    v_mfma_f32_4x4x4_16b_bf16 v[112:115], v[236:237], v[236:237], v[112:115]
    s_nop 0
    v_mfma_f32_4x4x4_16b_bf16 v[108:111], v[104:105], v[238:239], v[108:111]
    v_mfma_f32_4x4x4_16b_bf16 v[112:115], v[238:239], v[238:239], v[112:115]
    s_waitcnt lgkmcnt(4)
    v_mfma_f32_4x4x4_16b_bf16 v[108:111], v[104:105], v[240:241], v[108:111]
    v_mfma_f32_4x4x4_16b_bf16 v[112:115], v[240:241], v[240:241], v[112:115]
    v_mfma_f32_4x4x4_16b_bf16 v[116:119], v[104:105], v[80:81], v[116:119]
    v_mfma_f32_4x4x4_16b_bf16 v[120:123], v[104:105], v[84:85], v[120:123]
    v_mfma_f32_4x4x4_16b_bf16 v[108:111], v[104:105], v[242:243], v[108:111]
    v_mfma_f32_4x4x4_16b_bf16 v[112:115], v[242:243], v[242:243], v[112:115]
    v_mfma_f32_4x4x4_16b_bf16 v[116:119], v[104:105], v[82:83], v[116:119]
    v_mfma_f32_4x4x4_16b_bf16 v[120:123], v[104:105], v[86:87], v[120:123]
    v_mfma_f32_4x4x4_16b_bf16 v[108:111], v[104:105], v[244:245], v[108:111]
    v_mfma_f32_4x4x4_16b_bf16 v[112:115], v[244:245], v[244:245], v[112:115]
    s_nop 0
    v_mfma_f32_4x4x4_16b_bf16 v[108:111], v[104:105], v[246:247], v[108:111]
    v_mfma_f32_4x4x4_16b_bf16 v[112:115], v[246:247], v[246:247], v[112:115]
    s_nop 0
    v_mfma_f32_4x4x4_16b_bf16 v[108:111], v[104:105], v[248:249], v[108:111]
    v_mfma_f32_4x4x4_16b_bf16 v[112:115], v[248:249], v[248:249], v[112:115]
    s_nop 0
    v_mfma_f32_4x4x4_16b_bf16 v[108:111], v[104:105], v[250:251], v[108:111]
    v_mfma_f32_4x4x4_16b_bf16 v[112:115], v[250:251], v[250:251], v[112:115]
    s_nop 0
    v_mfma_f32_4x4x4_16b_bf16 v[108:111], v[104:105], v[252:253], v[108:111]
    v_mfma_f32_4x4x4_16b_bf16 v[112:115], v[252:253], v[252:253], v[112:115]
    s_nop 0
    v_mfma_f32_4x4x4_16b_bf16 v[108:111], v[104:105], v[254:255], v[108:111]
    v_mfma_f32_4x4x4_16b_bf16 v[112:115], v[254:255], v[254:255], v[112:115]
    s_waitcnt lgkmcnt(7)
    v_mfma_f32_32x32x16_bf16 v[16:31], v[80:83], v[240:243], v[16:31]
    s_lshl_b32 s32, s24, 2
    s_add_u32 s32, s32, 155648
    v_lshl_add_u32 v11, v1, 4, s32
    v_mov_b32 v12, v116
    v_mov_b32 v13, v120
    s_nop 1
    v_permlane32_swap_b32 v12, v13
    ds_read_b64_tr_b16 v[96:97], v126 offset:8192
    ds_read_b64_tr_b16 v[98:99], v126 offset:8704
    ds_read_b64_tr_b16 v[100:101], v130 offset:8192
    ds_read_b64_tr_b16 v[102:103], v130 offset:8704
    v_mfma_f32_32x32x16_bf16 v[32:47], v[84:87], v[240:243], v[32:47]
    v_add_f32 v12, v12, v13
    v_cvt_pk_bf16_f32 v13, v12, v12
    v_and_b32 v13, 0xffff0000, v13
    v_sub_f32 v12, v12, v13
    v_cvt_pk_bf16_f32 v12, v13, v12
    ds_write_b32 v11, v12
    s_waitcnt lgkmcnt(5)
    v_mfma_f32_32x32x16_bf16 v[16:31], v[88:91], v[244:247], v[16:31]
    v_cndmask_b32 v112, v112, v113, s[52:53]
    v_cndmask_b32 v113, v114, v115, s[52:53]
    v_cndmask_b32 v14, v112, v113, s[54:55]
    v_mov_b32 v15, v108
    v_mov_b32 v12, v14
    s_nop 1
    v_permlane32_swap_b32 v14, v12
    ds_read_b64_tr_b16 v[80:81], v127 offset:8192
    ds_read_b64_tr_b16 v[82:83], v127 offset:8704
    ds_read_b64_tr_b16 v[84:85], v131 offset:8192
    ds_read_b64_tr_b16 v[86:87], v131 offset:8704
    v_mfma_f32_32x32x16_bf16 v[32:47], v[92:95], v[244:247], v[32:47]
    v_add_f32 v14, v14, v12
    v_mov_b32 v13, v15
    s_nop 1
    v_permlane32_swap_b32 v15, v13
    v_add_f32 v15, v15, v13
    v_and_b32 v11, 31, v1
    v_lshlrev_b32 v11, 4, v11
    s_waitcnt lgkmcnt(5)
    v_mfma_f32_32x32x16_bf16 v[16:31], v[96:99], v[248:251], v[16:31]
    v_add_u32 v11, 155648, v11
    s_waitcnt lgkmcnt(0)
    s_barrier
    ds_read_b128 v[116:119], v11
    ds_read_b128 v[120:123], v11 offset:512
    v_mul_f32 v15, 0x3b124925, v15
    v_mul_f32 v14, 0x3b124925, v14
    v_mfma_f32_32x32x16_bf16 v[32:47], v[100:103], v[248:251], v[32:47]
    v_fma_f32 v112, -v15, v15, v14
    v_max_f32 v112, 0, v112
    v_cvt_pk_bf16_f32 v114, v15, v15
    v_and_b32 v114, 0xffff0000, v114
    v_cvt_pk_bf16_f32 v112, v112, v112
    v_and_b32 v112, 0xffff0000, v112
    s_waitcnt lgkmcnt(2)
    v_mfma_f32_32x32x16_bf16 v[16:31], v[80:83], v[252:255], v[16:31]
    v_add_f32 v112, 0x3727c5ac, v112
    v_cvt_pk_bf16_f32 v112, v112, v112
    v_and_b32 v112, 0xffff0000, v112
    v_sqrt_f32 v112, v112
    s_nop 0
    v_cvt_pk_bf16_f32 v112, v112, v112
    v_and_b32 v112, 0xffff0000, v112
    v_mfma_f32_32x32x16_bf16 v[32:47], v[84:87], v[252:255], v[32:47]
    v_rcp_f32 v115, v112
    v_lshrrev_b32 v14, 16, v114
    v_or_b32 v14, v14, v114
    v_xor_b32 v14, 0x80008000, v14
    v_cndmask_b32 v108, v14, 0, s[40:41]
    v_cndmask_b32 v109, v14, 0, s[40:41]
    v_cndmask_b32 v110, v14, 0, s[40:41]
    v_cndmask_b32 v111, v14, 0, s[40:41]
    s_waitcnt lgkmcnt(0)
    s_nop 0
    v_mfma_f32_32x32x16_bf16 v[16:31], v[116:119], v[108:111], v[16:31]
    v_mfma_f32_32x32x16_bf16 v[32:47], v[120:123], v[108:111], v[32:47]
    v_mul_f32 v140, 0xc0135761, v115
    v_mul_f32 v142, v115, v115
    v_mul_f32 v142, v142, v115
    v_mul_f32 v142, 0xbdd2d3e8, v142
    s_nop 6
    v_pk_mul_f32 v[88:89], v[16:17], v[16:17]
    v_pk_mul_f32 v[90:91], v[18:19], v[18:19]
    v_pk_mul_f32 v[92:93], v[20:21], v[20:21]
    v_pk_mul_f32 v[94:95], v[22:23], v[22:23]
    v_pk_fma_f32 v[88:89], v[88:89], v[142:143], v[140:141] op_sel_hi:[1,0,0]
    v_pk_fma_f32 v[90:91], v[90:91], v[142:143], v[140:141] op_sel_hi:[1,0,0]
    v_pk_fma_f32 v[92:93], v[92:93], v[142:143], v[140:141] op_sel_hi:[1,0,0]
    v_pk_fma_f32 v[94:95], v[94:95], v[142:143], v[140:141] op_sel_hi:[1,0,0]
    v_pk_mul_f32 v[88:89], v[88:89], v[16:17]
    v_pk_mul_f32 v[90:91], v[90:91], v[18:19]
    v_pk_mul_f32 v[92:93], v[92:93], v[20:21]
    v_pk_mul_f32 v[94:95], v[94:95], v[22:23]
    v_exp_f32 v88, v88
    v_exp_f32 v89, v89
    v_exp_f32 v90, v90
    v_exp_f32 v91, v91
    v_exp_f32 v92, v92
    v_exp_f32 v93, v93
    v_exp_f32 v94, v94
    v_exp_f32 v95, v95
    v_pk_fma_f32 v[88:89], v[88:89], v[112:113], v[112:113] op_sel_hi:[1,0,0]
    v_pk_fma_f32 v[90:91], v[90:91], v[112:113], v[112:113] op_sel_hi:[1,0,0]
    v_pk_fma_f32 v[92:93], v[92:93], v[112:113], v[112:113] op_sel_hi:[1,0,0]
    v_pk_fma_f32 v[94:95], v[94:95], v[112:113], v[112:113] op_sel_hi:[1,0,0]
    v_rcp_f32 v88, v88
    v_rcp_f32 v89, v89
    v_rcp_f32 v90, v90
    v_rcp_f32 v91, v91
    v_rcp_f32 v92, v92
    v_rcp_f32 v93, v93
    v_rcp_f32 v94, v94
    v_rcp_f32 v95, v95
    v_pk_mul_f32 v[16:17], v[16:17], v[88:89]
    v_pk_mul_f32 v[18:19], v[18:19], v[90:91]
    v_pk_mul_f32 v[20:21], v[20:21], v[92:93]
    v_pk_mul_f32 v[22:23], v[22:23], v[94:95]
    v_pk_mul_f32 v[6:7], v[16:17], v[16:17]
    v_pk_mul_f32 v[8:9], v[18:19], v[18:19]
    v_pk_fma_f32 v[6:7], v[20:21], v[20:21], v[6:7]
    v_pk_add_f32 v[2:3], v[20:21], v[16:17]
    v_pk_fma_f32 v[8:9], v[22:23], v[22:23], v[8:9]
    v_pk_add_f32 v[4:5], v[22:23], v[18:19]
    v_pk_mul_f32 v[88:89], v[24:25], v[24:25]
    v_pk_mul_f32 v[90:91], v[26:27], v[26:27]
    v_pk_mul_f32 v[92:93], v[28:29], v[28:29]
    v_pk_mul_f32 v[94:95], v[30:31], v[30:31]
    v_pk_fma_f32 v[88:89], v[88:89], v[142:143], v[140:141] op_sel_hi:[1,0,0]
    v_pk_fma_f32 v[90:91], v[90:91], v[142:143], v[140:141] op_sel_hi:[1,0,0]
    v_pk_fma_f32 v[92:93], v[92:93], v[142:143], v[140:141] op_sel_hi:[1,0,0]
    v_pk_fma_f32 v[94:95], v[94:95], v[142:143], v[140:141] op_sel_hi:[1,0,0]
    v_pk_mul_f32 v[88:89], v[88:89], v[24:25]
    v_pk_mul_f32 v[90:91], v[90:91], v[26:27]
    v_pk_mul_f32 v[92:93], v[92:93], v[28:29]
    v_pk_mul_f32 v[94:95], v[94:95], v[30:31]
    v_exp_f32 v88, v88
    v_exp_f32 v89, v89
    v_exp_f32 v90, v90
    v_exp_f32 v91, v91
    v_exp_f32 v92, v92
    v_exp_f32 v93, v93
    v_exp_f32 v94, v94
    v_exp_f32 v95, v95
    v_pk_fma_f32 v[88:89], v[88:89], v[112:113], v[112:113] op_sel_hi:[1,0,0]
    v_pk_fma_f32 v[90:91], v[90:91], v[112:113], v[112:113] op_sel_hi:[1,0,0]
    v_pk_fma_f32 v[92:93], v[92:93], v[112:113], v[112:113] op_sel_hi:[1,0,0]
    v_pk_fma_f32 v[94:95], v[94:95], v[112:113], v[112:113] op_sel_hi:[1,0,0]
    v_rcp_f32 v88, v88
    v_rcp_f32 v89, v89
    v_rcp_f32 v90, v90
    v_rcp_f32 v91, v91
    v_rcp_f32 v92, v92
    v_rcp_f32 v93, v93
    v_rcp_f32 v94, v94
    v_rcp_f32 v95, v95
    v_pk_mul_f32 v[24:25], v[24:25], v[88:89]
    v_pk_mul_f32 v[26:27], v[26:27], v[90:91]
    v_pk_mul_f32 v[28:29], v[28:29], v[92:93]
    v_pk_mul_f32 v[30:31], v[30:31], v[94:95]
    v_pk_fma_f32 v[6:7], v[24:25], v[24:25], v[6:7]
    v_pk_add_f32 v[2:3], v[24:25], v[2:3]
    v_pk_fma_f32 v[8:9], v[26:27], v[26:27], v[8:9]
    v_pk_add_f32 v[4:5], v[26:27], v[4:5]
    v_pk_fma_f32 v[6:7], v[28:29], v[28:29], v[6:7]
    v_pk_add_f32 v[2:3], v[28:29], v[2:3]
    v_pk_fma_f32 v[8:9], v[30:31], v[30:31], v[8:9]
    v_pk_add_f32 v[4:5], v[30:31], v[4:5]
    v_pk_mul_f32 v[88:89], v[32:33], v[32:33]
    v_pk_mul_f32 v[90:91], v[34:35], v[34:35]
    v_pk_mul_f32 v[92:93], v[36:37], v[36:37]
    v_pk_mul_f32 v[94:95], v[38:39], v[38:39]
    v_pk_fma_f32 v[88:89], v[88:89], v[142:143], v[140:141] op_sel_hi:[1,0,0]
    v_pk_fma_f32 v[90:91], v[90:91], v[142:143], v[140:141] op_sel_hi:[1,0,0]
    v_pk_fma_f32 v[92:93], v[92:93], v[142:143], v[140:141] op_sel_hi:[1,0,0]
    v_pk_fma_f32 v[94:95], v[94:95], v[142:143], v[140:141] op_sel_hi:[1,0,0]
    v_pk_mul_f32 v[88:89], v[88:89], v[32:33]
    v_pk_mul_f32 v[90:91], v[90:91], v[34:35]
    v_pk_mul_f32 v[92:93], v[92:93], v[36:37]
    v_pk_mul_f32 v[94:95], v[94:95], v[38:39]
    v_exp_f32 v88, v88
    v_exp_f32 v89, v89
    v_exp_f32 v90, v90
    v_exp_f32 v91, v91
    v_exp_f32 v92, v92
    v_exp_f32 v93, v93
    v_exp_f32 v94, v94
    v_exp_f32 v95, v95
    v_pk_fma_f32 v[88:89], v[88:89], v[112:113], v[112:113] op_sel_hi:[1,0,0]
    v_pk_fma_f32 v[90:91], v[90:91], v[112:113], v[112:113] op_sel_hi:[1,0,0]
    v_pk_fma_f32 v[92:93], v[92:93], v[112:113], v[112:113] op_sel_hi:[1,0,0]
    v_pk_fma_f32 v[94:95], v[94:95], v[112:113], v[112:113] op_sel_hi:[1,0,0]
    v_rcp_f32 v88, v88
    v_rcp_f32 v89, v89
    v_rcp_f32 v90, v90
    v_rcp_f32 v91, v91
    v_rcp_f32 v92, v92
    v_rcp_f32 v93, v93
    v_rcp_f32 v94, v94
    v_rcp_f32 v95, v95
    v_pk_mul_f32 v[32:33], v[32:33], v[88:89]
    v_pk_mul_f32 v[34:35], v[34:35], v[90:91]
    v_pk_mul_f32 v[36:37], v[36:37], v[92:93]
    v_pk_mul_f32 v[38:39], v[38:39], v[94:95]
    v_pk_fma_f32 v[6:7], v[32:33], v[32:33], v[6:7]
    v_pk_add_f32 v[2:3], v[32:33], v[2:3]
    v_pk_fma_f32 v[8:9], v[34:35], v[34:35], v[8:9]
    v_pk_add_f32 v[4:5], v[34:35], v[4:5]
    v_pk_fma_f32 v[6:7], v[36:37], v[36:37], v[6:7]
    v_pk_add_f32 v[2:3], v[36:37], v[2:3]
    v_pk_fma_f32 v[8:9], v[38:39], v[38:39], v[8:9]
    v_pk_add_f32 v[4:5], v[38:39], v[4:5]
    v_pk_mul_f32 v[88:89], v[40:41], v[40:41]
    v_pk_mul_f32 v[90:91], v[42:43], v[42:43]
    v_pk_mul_f32 v[92:93], v[44:45], v[44:45]
    v_pk_mul_f32 v[94:95], v[46:47], v[46:47]
    v_pk_fma_f32 v[88:89], v[88:89], v[142:143], v[140:141] op_sel_hi:[1,0,0]
    v_pk_fma_f32 v[90:91], v[90:91], v[142:143], v[140:141] op_sel_hi:[1,0,0]
    v_pk_fma_f32 v[92:93], v[92:93], v[142:143], v[140:141] op_sel_hi:[1,0,0]
    v_pk_fma_f32 v[94:95], v[94:95], v[142:143], v[140:141] op_sel_hi:[1,0,0]
    v_pk_mul_f32 v[88:89], v[88:89], v[40:41]
    v_pk_mul_f32 v[90:91], v[90:91], v[42:43]
    v_pk_mul_f32 v[92:93], v[92:93], v[44:45]
    v_pk_mul_f32 v[94:95], v[94:95], v[46:47]
    v_exp_f32 v88, v88
    v_exp_f32 v89, v89
    v_exp_f32 v90, v90
    v_exp_f32 v91, v91
    v_exp_f32 v92, v92
    v_exp_f32 v93, v93
    v_exp_f32 v94, v94
    v_exp_f32 v95, v95
    v_pk_fma_f32 v[88:89], v[88:89], v[112:113], v[112:113] op_sel_hi:[1,0,0]
    v_pk_fma_f32 v[90:91], v[90:91], v[112:113], v[112:113] op_sel_hi:[1,0,0]
    v_pk_fma_f32 v[92:93], v[92:93], v[112:113], v[112:113] op_sel_hi:[1,0,0]
    v_pk_fma_f32 v[94:95], v[94:95], v[112:113], v[112:113] op_sel_hi:[1,0,0]
    v_rcp_f32 v88, v88
    v_rcp_f32 v89, v89
    v_rcp_f32 v90, v90
    v_rcp_f32 v91, v91
    v_rcp_f32 v92, v92
    v_rcp_f32 v93, v93
    v_rcp_f32 v94, v94
    v_rcp_f32 v95, v95
    v_pk_mul_f32 v[40:41], v[40:41], v[88:89]
    v_pk_mul_f32 v[42:43], v[42:43], v[90:91]
    v_pk_mul_f32 v[44:45], v[44:45], v[92:93]
    v_pk_mul_f32 v[46:47], v[46:47], v[94:95]
    v_pk_fma_f32 v[6:7], v[40:41], v[40:41], v[6:7]
    v_pk_add_f32 v[2:3], v[40:41], v[2:3]
    v_pk_fma_f32 v[8:9], v[42:43], v[42:43], v[8:9]
    v_pk_add_f32 v[4:5], v[42:43], v[4:5]
    v_pk_fma_f32 v[6:7], v[44:45], v[44:45], v[6:7]
    v_pk_add_f32 v[2:3], v[44:45], v[2:3]
    v_pk_fma_f32 v[8:9], v[46:47], v[46:47], v[8:9]
    v_pk_add_f32 v[4:5], v[46:47], v[4:5]
    v_pk_add_f32 v[2:3], v[2:3], v[4:5]
    v_pk_add_f32 v[6:7], v[6:7], v[8:9]
    v_add_f32 v100, v2, v3
    v_add_f32 v102, v6, v7
    v_mov_b32 v14, v100
    s_nop 1
    v_permlane32_swap_b32 v100, v14
    v_add_f32 v100, v100, v14
    v_mov_b32 v15, v102
    s_nop 1
    v_permlane32_swap_b32 v102, v15
    v_add_f32 v102, v102, v15
    s_waitcnt vmcnt(0)
    s_mov_b32 s50, 0
F_n1_r:
    v_readfirstlane_b32 s51, v107
    s_nop 1
    s_cmp_lg_u32 s51, 0
    s_cbranch_scc1 F_n1_ok
    s_add_u32 s50, s50, 1
    s_cmp_gt_u32 s50, 0x100000
    s_cbranch_scc1 F_n1_ok
    s_sleep 1
    v_mov_b32 v11, 0
    global_load_dwordx2 v[106:107], v11, s[8:9] sc1
    s_waitcnt vmcnt(0)
    s_branch F_n1_r
F_n1_ok:
    v_mov_b32 v101, v106
    v_mov_b32 v103, v107
    s_mul_i32 s42, s34, 7168
    s_add_u32 s42, s42, 20971520
    s_lshl_b32 s32, s26, 9
    s_add_u32 s32, s32, s42
    v_and_b32 v11, 31, v1
    v_lshlrev_b32 v11, 4, v11
    buffer_store_dwordx4 v[100:103], v11, s[20:23], s32 offen sc1
    s_waitcnt vmcnt(2)
    s_barrier
    ds_read_b64_tr_b16 v[88:89], v132 offset:0
    ds_read_b64_tr_b16 v[90:91], v132 offset:512
    ds_read_b64_tr_b16 v[92:93], v136 offset:0
    ds_read_b64_tr_b16 v[94:95], v136 offset:512
    ds_read_b64_tr_b16 v[96:97], v133 offset:0
    ds_read_b64_tr_b16 v[98:99], v133 offset:512
    ds_read_b64_tr_b16 v[100:101], v137 offset:0
    ds_read_b64_tr_b16 v[102:103], v137 offset:512
    s_waitcnt lgkmcnt(4)
    v_mfma_f32_32x32x16_bf16 v[48:63], v[88:91], v[144:147], 0
    v_and_b32 v15, 31, v1
    ds_read_b64_tr_b16 v[80:81], v134 offset:0
    ds_read_b64_tr_b16 v[82:83], v134 offset:512
    ds_read_b64_tr_b16 v[84:85], v138 offset:0
    ds_read_b64_tr_b16 v[86:87], v138 offset:512
    v_mfma_f32_32x32x16_bf16 v[64:79], v[92:95], v[144:147], 0
    v_lshlrev_b32 v15, 4, v15
    v_mfma_f32_4x4x4_16b_bf16 v[116:119], v[104:105], v[88:89], 0
    v_mfma_f32_4x4x4_16b_bf16 v[120:123], v[104:105], v[92:93], 0
    s_nop 0
    v_mfma_f32_4x4x4_16b_bf16 v[116:119], v[104:105], v[90:91], v[116:119]
    v_mfma_f32_4x4x4_16b_bf16 v[120:123], v[104:105], v[94:95], v[120:123]
    s_waitcnt lgkmcnt(4)
    v_mfma_f32_32x32x16_bf16 v[48:63], v[96:99], v[148:151], v[48:63]
    v_lshrrev_b32 v14, 5, v1
    ds_read_b64_tr_b16 v[88:89], v135 offset:0
    ds_read_b64_tr_b16 v[90:91], v135 offset:512
    ds_read_b64_tr_b16 v[92:93], v139 offset:0
    ds_read_b64_tr_b16 v[94:95], v139 offset:512
    v_mfma_f32_32x32x16_bf16 v[64:79], v[100:103], v[148:151], v[64:79]
    v_mul_u32_u24 v14, 3584, v14
    s_waitcnt lgkmcnt(4)
    v_mfma_f32_32x32x16_bf16 v[48:63], v[80:83], v[152:155], v[48:63]
    v_add_u32 v15, v15, v14
    ds_read_b64_tr_b16 v[96:97], v124 offset:16384
    ds_read_b64_tr_b16 v[98:99], v124 offset:16896
    ds_read_b64_tr_b16 v[100:101], v128 offset:16384
    ds_read_b64_tr_b16 v[102:103], v128 offset:16896
    v_mfma_f32_32x32x16_bf16 v[64:79], v[84:87], v[152:155], v[64:79]
    v_and_b32 v5, 31, v1
    s_waitcnt lgkmcnt(4)
    v_mfma_f32_32x32x16_bf16 v[48:63], v[88:91], v[156:159], v[48:63]
    v_lshlrev_b32 v6, 6, v5
    ds_read_b64_tr_b16 v[80:81], v125 offset:16384
    ds_read_b64_tr_b16 v[82:83], v125 offset:16896
    ds_read_b64_tr_b16 v[84:85], v129 offset:16384
    ds_read_b64_tr_b16 v[86:87], v129 offset:16896
    v_mfma_f32_32x32x16_bf16 v[64:79], v[92:95], v[156:159], v[64:79]
    v_add_u32 v6, s47, v6
    s_waitcnt lgkmcnt(4)
    v_mfma_f32_32x32x16_bf16 v[48:63], v[96:99], v[160:163], v[48:63]
    v_add_u32 v6, 102400, v6
    ds_read_b64_tr_b16 v[88:89], v126 offset:16384
    ds_read_b64_tr_b16 v[90:91], v126 offset:16896
    ds_read_b64_tr_b16 v[92:93], v130 offset:16384
    ds_read_b64_tr_b16 v[94:95], v130 offset:16896
    v_mfma_f32_32x32x16_bf16 v[64:79], v[100:103], v[160:163], v[64:79]
    v_lshrrev_b32 v7, 5, v1
    v_mfma_f32_4x4x4_16b_bf16 v[116:119], v[104:105], v[96:97], v[116:119]
    v_mfma_f32_4x4x4_16b_bf16 v[120:123], v[104:105], v[100:101], v[120:123]
    s_nop 0
    v_mfma_f32_4x4x4_16b_bf16 v[116:119], v[104:105], v[98:99], v[116:119]
    v_mfma_f32_4x4x4_16b_bf16 v[120:123], v[104:105], v[102:103], v[120:123]
    s_waitcnt lgkmcnt(4)
    v_mfma_f32_32x32x16_bf16 v[48:63], v[80:83], v[164:167], v[48:63]
    v_bfe_u32 v8, v1, 1, 3
    ds_read_b64_tr_b16 v[96:97], v127 offset:16384
    ds_read_b64_tr_b16 v[98:99], v127 offset:16896
    ds_read_b64_tr_b16 v[100:101], v131 offset:16384
    ds_read_b64_tr_b16 v[102:103], v131 offset:16896
    v_mfma_f32_32x32x16_bf16 v[64:79], v[84:87], v[164:167], v[64:79]
    v_xor_b32 v8, v8, v7
    s_waitcnt lgkmcnt(4)
    v_mfma_f32_32x32x16_bf16 v[48:63], v[88:91], v[168:171], v[48:63]
    v_lshl_add_u32 v2, v8, 3, v6
    ds_read_b64_tr_b16 v[80:81], v124 offset:24576
    ds_read_b64_tr_b16 v[82:83], v124 offset:25088
    ds_read_b64_tr_b16 v[84:85], v128 offset:24576
    ds_read_b64_tr_b16 v[86:87], v128 offset:25088
    v_mfma_f32_32x32x16_bf16 v[64:79], v[92:95], v[168:171], v[64:79]
    v_bfe_u32 v5, v1, 2, 2
    s_waitcnt lgkmcnt(4)
    v_mfma_f32_32x32x16_bf16 v[48:63], v[96:99], v[172:175], v[48:63]
    v_lshl_add_u32 v5, v7, 3, v5
    ds_read_b64_tr_b16 v[88:89], v125 offset:24576
    ds_read_b64_tr_b16 v[90:91], v125 offset:25088
    ds_read_b64_tr_b16 v[92:93], v129 offset:24576
    ds_read_b64_tr_b16 v[94:95], v129 offset:25088
    v_mfma_f32_32x32x16_bf16 v[64:79], v[100:103], v[172:175], v[64:79]
    v_lshlrev_b32 v5, 6, v5
    s_waitcnt lgkmcnt(4)
    v_mfma_f32_32x32x16_bf16 v[48:63], v[80:83], v[176:179], v[48:63]
    v_add_u32 v5, s47, v5
    ds_read_b64_tr_b16 v[96:97], v126 offset:24576
    ds_read_b64_tr_b16 v[98:99], v126 offset:25088
    ds_read_b64_tr_b16 v[100:101], v130 offset:24576
    ds_read_b64_tr_b16 v[102:103], v130 offset:25088
    v_mfma_f32_32x32x16_bf16 v[64:79], v[84:87], v[176:179], v[64:79]
    v_add_u32 v5, 102400, v5
    v_mfma_f32_4x4x4_16b_bf16 v[116:119], v[104:105], v[80:81], v[116:119]
    v_mfma_f32_4x4x4_16b_bf16 v[120:123], v[104:105], v[84:85], v[120:123]
    s_nop 0
    v_mfma_f32_4x4x4_16b_bf16 v[116:119], v[104:105], v[82:83], v[116:119]
    v_mfma_f32_4x4x4_16b_bf16 v[120:123], v[104:105], v[86:87], v[120:123]
    s_waitcnt lgkmcnt(4)
    v_mfma_f32_32x32x16_bf16 v[48:63], v[88:91], v[180:183], v[48:63]
    v_and_b32 v6, 3, v1
    ds_read_b64_tr_b16 v[80:81], v127 offset:24576
    ds_read_b64_tr_b16 v[82:83], v127 offset:25088
    ds_read_b64_tr_b16 v[84:85], v131 offset:24576
    ds_read_b64_tr_b16 v[86:87], v131 offset:25088
    v_mfma_f32_32x32x16_bf16 v[64:79], v[92:95], v[180:183], v[64:79]
    v_bfe_u32 v8, v1, 4, 1
    s_waitcnt lgkmcnt(4)
    v_mfma_f32_32x32x16_bf16 v[48:63], v[96:99], v[184:187], v[48:63]
    v_xor_b32 v8, v8, v7
    ds_read_b64_tr_b16 v[88:89], v132 offset:8192
    ds_read_b64_tr_b16 v[90:91], v132 offset:8704
    ds_read_b64_tr_b16 v[92:93], v136 offset:8192
    ds_read_b64_tr_b16 v[94:95], v136 offset:8704
    v_mfma_f32_32x32x16_bf16 v[64:79], v[100:103], v[184:187], v[64:79]
    v_lshl_or_b32 v6, v8, 2, v6
    s_waitcnt lgkmcnt(4)
    v_mfma_f32_32x32x16_bf16 v[48:63], v[80:83], v[188:191], v[48:63]
    v_bfe_u32 v8, v1, 3, 1
    ds_read_b64_tr_b16 v[96:97], v133 offset:8192
    ds_read_b64_tr_b16 v[98:99], v133 offset:8704
    ds_read_b64_tr_b16 v[100:101], v137 offset:8192
    ds_read_b64_tr_b16 v[102:103], v137 offset:8704
    v_mfma_f32_32x32x16_bf16 v[64:79], v[84:87], v[188:191], v[64:79]
    v_xor_b32 v6, v6, v8
    s_waitcnt lgkmcnt(4)
    v_mfma_f32_32x32x16_bf16 v[48:63], v[88:91], v[192:195], v[48:63]
    v_lshl_add_u32 v3, v6, 3, v5
    ds_read_b64_tr_b16 v[80:81], v134 offset:8192
    ds_read_b64_tr_b16 v[82:83], v134 offset:8704
    ds_read_b64_tr_b16 v[84:85], v138 offset:8192
    ds_read_b64_tr_b16 v[86:87], v138 offset:8704
    v_mfma_f32_32x32x16_bf16 v[64:79], v[92:95], v[192:195], v[64:79]
    v_lshlrev_b32 v4, 4, v1
    v_mfma_f32_4x4x4_16b_bf16 v[116:119], v[104:105], v[88:89], v[116:119]
    v_mfma_f32_4x4x4_16b_bf16 v[120:123], v[104:105], v[92:93], v[120:123]
    s_nop 0
    v_mfma_f32_4x4x4_16b_bf16 v[116:119], v[104:105], v[90:91], v[116:119]
    v_mfma_f32_4x4x4_16b_bf16 v[120:123], v[104:105], v[94:95], v[120:123]
    s_waitcnt lgkmcnt(4)
    v_mfma_f32_32x32x16_bf16 v[48:63], v[96:99], v[196:199], v[48:63]
    ds_read_b64_tr_b16 v[88:89], v135 offset:8192
    ds_read_b64_tr_b16 v[90:91], v135 offset:8704
    ds_read_b64_tr_b16 v[92:93], v139 offset:8192
    ds_read_b64_tr_b16 v[94:95], v139 offset:8704
    v_mfma_f32_32x32x16_bf16 v[64:79], v[100:103], v[196:199], v[64:79]
    s_waitcnt lgkmcnt(4)
    v_mfma_f32_32x32x16_bf16 v[48:63], v[80:83], v[200:203], v[48:63]
    ds_read_b64_tr_b16 v[96:97], v124 offset:32768
    ds_read_b64_tr_b16 v[98:99], v124 offset:33280
    ds_read_b64_tr_b16 v[100:101], v128 offset:32768
    ds_read_b64_tr_b16 v[102:103], v128 offset:33280
    v_mfma_f32_32x32x16_bf16 v[64:79], v[84:87], v[200:203], v[64:79]
    s_waitcnt lgkmcnt(4)
    v_mfma_f32_32x32x16_bf16 v[48:63], v[88:91], v[204:207], v[48:63]
    ds_read_b64_tr_b16 v[80:81], v125 offset:32768
    ds_read_b64_tr_b16 v[82:83], v125 offset:33280
    ds_read_b64_tr_b16 v[84:85], v129 offset:32768
    ds_read_b64_tr_b16 v[86:87], v129 offset:33280
    v_mfma_f32_32x32x16_bf16 v[64:79], v[92:95], v[204:207], v[64:79]
    s_waitcnt lgkmcnt(4)
    v_mfma_f32_32x32x16_bf16 v[48:63], v[96:99], v[208:211], v[48:63]
    ds_read_b64_tr_b16 v[88:89], v126 offset:32768
    ds_read_b64_tr_b16 v[90:91], v126 offset:33280
    ds_read_b64_tr_b16 v[92:93], v130 offset:32768
    ds_read_b64_tr_b16 v[94:95], v130 offset:33280
    v_mfma_f32_32x32x16_bf16 v[64:79], v[100:103], v[208:211], v[64:79]
    v_mfma_f32_4x4x4_16b_bf16 v[116:119], v[104:105], v[96:97], v[116:119]
    v_mfma_f32_4x4x4_16b_bf16 v[120:123], v[104:105], v[100:101], v[120:123]
    s_nop 0
    v_mfma_f32_4x4x4_16b_bf16 v[116:119], v[104:105], v[98:99], v[116:119]
    v_mfma_f32_4x4x4_16b_bf16 v[120:123], v[104:105], v[102:103], v[120:123]
    s_waitcnt lgkmcnt(4)
    v_mfma_f32_32x32x16_bf16 v[48:63], v[80:83], v[212:215], v[48:63]
    ds_read_b64_tr_b16 v[96:97], v127 offset:32768
    ds_read_b64_tr_b16 v[98:99], v127 offset:33280
    ds_read_b64_tr_b16 v[100:101], v131 offset:32768
    ds_read_b64_tr_b16 v[102:103], v131 offset:33280
    v_mfma_f32_32x32x16_bf16 v[64:79], v[84:87], v[212:215], v[64:79]
    s_waitcnt lgkmcnt(4)
    v_mfma_f32_32x32x16_bf16 v[48:63], v[88:91], v[216:219], v[48:63]
    ds_read_b64_tr_b16 v[80:81], v124 offset:40960
    ds_read_b64_tr_b16 v[82:83], v124 offset:41472
    ds_read_b64_tr_b16 v[84:85], v128 offset:40960
    ds_read_b64_tr_b16 v[86:87], v128 offset:41472
    v_mfma_f32_32x32x16_bf16 v[64:79], v[92:95], v[216:219], v[64:79]
    s_waitcnt lgkmcnt(4)
    v_mfma_f32_32x32x16_bf16 v[48:63], v[96:99], v[220:223], v[48:63]
    ds_read_b64_tr_b16 v[88:89], v125 offset:40960
    ds_read_b64_tr_b16 v[90:91], v125 offset:41472
    ds_read_b64_tr_b16 v[92:93], v129 offset:40960
    ds_read_b64_tr_b16 v[94:95], v129 offset:41472
    v_mfma_f32_32x32x16_bf16 v[64:79], v[100:103], v[220:223], v[64:79]
    s_waitcnt lgkmcnt(4)
    v_mfma_f32_32x32x16_bf16 v[48:63], v[80:83], v[224:227], v[48:63]
    ds_read_b64_tr_b16 v[96:97], v126 offset:40960
    ds_read_b64_tr_b16 v[98:99], v126 offset:41472
    ds_read_b64_tr_b16 v[100:101], v130 offset:40960
    ds_read_b64_tr_b16 v[102:103], v130 offset:41472
    v_mfma_f32_32x32x16_bf16 v[64:79], v[84:87], v[224:227], v[64:79]
    buffer_load_dwordx4 v[144:147], v15, s[20:23], s42 offen offset:0 sc1
    v_mfma_f32_4x4x4_16b_bf16 v[116:119], v[104:105], v[80:81], v[116:119]
    v_mfma_f32_4x4x4_16b_bf16 v[120:123], v[104:105], v[84:85], v[120:123]
    s_nop 0
    v_mfma_f32_4x4x4_16b_bf16 v[116:119], v[104:105], v[82:83], v[116:119]
    v_mfma_f32_4x4x4_16b_bf16 v[120:123], v[104:105], v[86:87], v[120:123]
    s_waitcnt lgkmcnt(4)
    v_mfma_f32_32x32x16_bf16 v[48:63], v[88:91], v[228:231], v[48:63]
    ds_read_b64_tr_b16 v[80:81], v127 offset:40960
    ds_read_b64_tr_b16 v[82:83], v127 offset:41472
    ds_read_b64_tr_b16 v[84:85], v131 offset:40960
    ds_read_b64_tr_b16 v[86:87], v131 offset:41472
    v_mfma_f32_32x32x16_bf16 v[64:79], v[92:95], v[228:231], v[64:79]
    buffer_load_dwordx4 v[148:151], v15, s[20:23], s42 offen offset:512 sc1
    s_waitcnt lgkmcnt(4)
    v_mfma_f32_32x32x16_bf16 v[48:63], v[96:99], v[232:235], v[48:63]
    ds_read_b64_tr_b16 v[88:89], v132 offset:16384
    ds_read_b64_tr_b16 v[90:91], v132 offset:16896
    ds_read_b64_tr_b16 v[92:93], v136 offset:16384
    ds_read_b64_tr_b16 v[94:95], v136 offset:16896
    v_mfma_f32_32x32x16_bf16 v[64:79], v[100:103], v[232:235], v[64:79]
    buffer_load_dwordx4 v[152:155], v15, s[20:23], s42 offen offset:1024 sc1
    s_waitcnt lgkmcnt(4)
    v_mfma_f32_32x32x16_bf16 v[48:63], v[80:83], v[236:239], v[48:63]
    ds_read_b64_tr_b16 v[96:97], v133 offset:16384
    ds_read_b64_tr_b16 v[98:99], v133 offset:16896
    ds_read_b64_tr_b16 v[100:101], v137 offset:16384
    ds_read_b64_tr_b16 v[102:103], v137 offset:16896
    v_mfma_f32_32x32x16_bf16 v[64:79], v[84:87], v[236:239], v[64:79]
    buffer_load_dwordx4 v[156:159], v15, s[20:23], s42 offen offset:1536 sc1
    s_waitcnt lgkmcnt(4)
    v_mfma_f32_32x32x16_bf16 v[48:63], v[88:91], v[240:243], v[48:63]
    ds_read_b64_tr_b16 v[80:81], v134 offset:16384
    ds_read_b64_tr_b16 v[82:83], v134 offset:16896
    ds_read_b64_tr_b16 v[84:85], v138 offset:16384
    ds_read_b64_tr_b16 v[86:87], v138 offset:16896
    v_mfma_f32_32x32x16_bf16 v[64:79], v[92:95], v[240:243], v[64:79]
    buffer_load_dwordx4 v[160:163], v15, s[20:23], s42 offen offset:2048 sc1
    v_mfma_f32_4x4x4_16b_bf16 v[116:119], v[104:105], v[88:89], v[116:119]
    v_mfma_f32_4x4x4_16b_bf16 v[120:123], v[104:105], v[92:93], v[120:123]
    s_nop 0
    v_mfma_f32_4x4x4_16b_bf16 v[116:119], v[104:105], v[90:91], v[116:119]
    v_mfma_f32_4x4x4_16b_bf16 v[120:123], v[104:105], v[94:95], v[120:123]
    s_waitcnt lgkmcnt(4)
    v_mfma_f32_32x32x16_bf16 v[48:63], v[96:99], v[244:247], v[48:63]
    s_lshl_b32 s32, s24, 2
    s_add_u32 s32, s32, 156672
    v_lshl_add_u32 v11, v1, 4, s32
    s_nop 1
    v_mov_b32 v12, v116
    v_mov_b32 v13, v120
    s_nop 1
    v_permlane32_swap_b32 v12, v13
    ds_read_b64_tr_b16 v[88:89], v135 offset:16384
    ds_read_b64_tr_b16 v[90:91], v135 offset:16896
    ds_read_b64_tr_b16 v[92:93], v139 offset:16384
    ds_read_b64_tr_b16 v[94:95], v139 offset:16896
    v_mfma_f32_32x32x16_bf16 v[64:79], v[100:103], v[244:247], v[64:79]
    v_add_f32 v12, v12, v13
    v_cvt_pk_bf16_f32 v13, v12, v12
    v_and_b32 v13, 0xffff0000, v13
    v_sub_f32 v12, v12, v13
    v_cvt_pk_bf16_f32 v12, v13, v12
    ds_write_b32 v11, v12
    buffer_load_dwordx4 v[164:167], v15, s[20:23], s42 offen offset:2560 sc1
    s_waitcnt lgkmcnt(5)
    v_mfma_f32_32x32x16_bf16 v[48:63], v[80:83], v[248:251], v[48:63]
    v_and_b32 v11, 31, v1
    v_lshlrev_b32 v11, 4, v11
    v_add_u32 v11, 156672, v11
    v_mfma_f32_32x32x16_bf16 v[64:79], v[84:87], v[248:251], v[64:79]
    s_waitcnt lgkmcnt(0)
    s_barrier
    ds_read_b128 v[116:119], v11
    ds_read_b128 v[120:123], v11 offset:512
    buffer_load_dwordx4 v[168:171], v15, s[20:23], s42 offen offset:3072 sc1
    s_waitcnt lgkmcnt(3)
    v_mfma_f32_32x32x16_bf16 v[48:63], v[88:91], v[252:255], v[48:63]
    v_mfma_f32_32x32x16_bf16 v[64:79], v[92:95], v[252:255], v[64:79]
    s_lshl_b32 s32, s26, 7
    s_add_u32 s32, s32, s34
    s_lshl_b32 s32, s32, 11
    s_add_u32 s33, s32, 131072
    s_waitcnt lgkmcnt(0)
    v_mfma_f32_32x32x16_bf16 v[48:63], v[116:119], v[108:111], v[48:63]
    v_mfma_f32_32x32x16_bf16 v[64:79], v[120:123], v[108:111], v[64:79]
    v_xor_b32 v128, 0, v2
    v_xor_b32 v129, 16, v2
    v_xor_b32 v130, 32, v2
    v_xor_b32 v131, 48, v2
    v_xor_b32 v136, 0, v3
    v_xor_b32 v137, 16, v3
    s_nop 4
    v_pk_mul_f32 v[88:89], v[48:49], v[48:49]
    v_pk_mul_f32 v[90:91], v[50:51], v[50:51]
    v_pk_mul_f32 v[92:93], v[52:53], v[52:53]
    v_pk_mul_f32 v[94:95], v[54:55], v[54:55]
    v_pk_fma_f32 v[88:89], v[88:89], v[142:143], v[140:141] op_sel_hi:[1,0,0]
    v_pk_fma_f32 v[90:91], v[90:91], v[142:143], v[140:141] op_sel_hi:[1,0,0]
    v_pk_fma_f32 v[92:93], v[92:93], v[142:143], v[140:141] op_sel_hi:[1,0,0]
    v_pk_fma_f32 v[94:95], v[94:95], v[142:143], v[140:141] op_sel_hi:[1,0,0]
    v_pk_mul_f32 v[88:89], v[88:89], v[48:49]
    v_pk_mul_f32 v[90:91], v[90:91], v[50:51]
    v_pk_mul_f32 v[92:93], v[92:93], v[52:53]
    v_pk_mul_f32 v[94:95], v[94:95], v[54:55]
    v_exp_f32 v88, v88
    v_exp_f32 v89, v89
    v_exp_f32 v90, v90
    v_exp_f32 v91, v91
    v_exp_f32 v92, v92
    v_exp_f32 v93, v93
    v_exp_f32 v94, v94
    v_exp_f32 v95, v95
    v_pk_fma_f32 v[88:89], v[88:89], v[112:113], v[112:113] op_sel_hi:[1,0,0]
    v_pk_fma_f32 v[90:91], v[90:91], v[112:113], v[112:113] op_sel_hi:[1,0,0]
    v_pk_fma_f32 v[92:93], v[92:93], v[112:113], v[112:113] op_sel_hi:[1,0,0]
    v_pk_fma_f32 v[94:95], v[94:95], v[112:113], v[112:113] op_sel_hi:[1,0,0]
    v_rcp_f32 v88, v88
    v_rcp_f32 v89, v89
    v_rcp_f32 v90, v90
    v_rcp_f32 v91, v91
    v_rcp_f32 v92, v92
    v_rcp_f32 v93, v93
    v_rcp_f32 v94, v94
    v_rcp_f32 v95, v95
    v_pk_mul_f32 v[48:49], v[48:49], v[88:89]
    v_pk_mul_f32 v[50:51], v[50:51], v[90:91]
    v_pk_mul_f32 v[52:53], v[52:53], v[92:93]
    v_pk_mul_f32 v[54:55], v[54:55], v[94:95]
    v_cvt_pk_bf16_f32 v48, v48, v49
    v_cvt_pk_bf16_f32 v49, v50, v51
    v_cvt_pk_bf16_f32 v50, v52, v53
    v_cvt_pk_bf16_f32 v51, v54, v55
    buffer_store_dwordx4 v[48:51], v4, s[20:23], s32 offen offset:0 sc1
    v_pk_mul_f32 v[88:89], v[56:57], v[56:57]
    v_pk_mul_f32 v[90:91], v[58:59], v[58:59]
    v_pk_mul_f32 v[92:93], v[60:61], v[60:61]
    v_pk_mul_f32 v[94:95], v[62:63], v[62:63]
    v_pk_fma_f32 v[88:89], v[88:89], v[142:143], v[140:141] op_sel_hi:[1,0,0]
    v_pk_fma_f32 v[90:91], v[90:91], v[142:143], v[140:141] op_sel_hi:[1,0,0]
    v_pk_fma_f32 v[92:93], v[92:93], v[142:143], v[140:141] op_sel_hi:[1,0,0]
    v_pk_fma_f32 v[94:95], v[94:95], v[142:143], v[140:141] op_sel_hi:[1,0,0]
    v_pk_mul_f32 v[88:89], v[88:89], v[56:57]
    v_pk_mul_f32 v[90:91], v[90:91], v[58:59]
    v_pk_mul_f32 v[92:93], v[92:93], v[60:61]
    v_pk_mul_f32 v[94:95], v[94:95], v[62:63]
    v_exp_f32 v88, v88
    v_exp_f32 v89, v89
    v_exp_f32 v90, v90
    v_exp_f32 v91, v91
    v_exp_f32 v92, v92
    v_exp_f32 v93, v93
    v_exp_f32 v94, v94
    v_exp_f32 v95, v95
    v_pk_fma_f32 v[88:89], v[88:89], v[112:113], v[112:113] op_sel_hi:[1,0,0]
    v_pk_fma_f32 v[90:91], v[90:91], v[112:113], v[112:113] op_sel_hi:[1,0,0]
    v_pk_fma_f32 v[92:93], v[92:93], v[112:113], v[112:113] op_sel_hi:[1,0,0]
    v_pk_fma_f32 v[94:95], v[94:95], v[112:113], v[112:113] op_sel_hi:[1,0,0]
    v_rcp_f32 v88, v88
    v_rcp_f32 v89, v89
    v_rcp_f32 v90, v90
    v_rcp_f32 v91, v91
    v_rcp_f32 v92, v92
    v_rcp_f32 v93, v93
    v_rcp_f32 v94, v94
    v_rcp_f32 v95, v95
    v_pk_mul_f32 v[56:57], v[56:57], v[88:89]
    v_pk_mul_f32 v[58:59], v[58:59], v[90:91]
    v_pk_mul_f32 v[60:61], v[60:61], v[92:93]
    v_pk_mul_f32 v[62:63], v[62:63], v[94:95]
    v_cvt_pk_bf16_f32 v52, v56, v57
    v_cvt_pk_bf16_f32 v53, v58, v59
    v_cvt_pk_bf16_f32 v54, v60, v61
    v_cvt_pk_bf16_f32 v55, v62, v63
    buffer_store_dwordx4 v[52:55], v4, s[20:23], s32 offen offset:1024 sc1
    v_pk_mul_f32 v[88:89], v[64:65], v[64:65]
    v_pk_mul_f32 v[90:91], v[66:67], v[66:67]
    v_pk_mul_f32 v[92:93], v[68:69], v[68:69]
    v_pk_mul_f32 v[94:95], v[70:71], v[70:71]
    v_pk_fma_f32 v[88:89], v[88:89], v[142:143], v[140:141] op_sel_hi:[1,0,0]
    v_pk_fma_f32 v[90:91], v[90:91], v[142:143], v[140:141] op_sel_hi:[1,0,0]
    v_pk_fma_f32 v[92:93], v[92:93], v[142:143], v[140:141] op_sel_hi:[1,0,0]
    v_pk_fma_f32 v[94:95], v[94:95], v[142:143], v[140:141] op_sel_hi:[1,0,0]
    v_pk_mul_f32 v[88:89], v[88:89], v[64:65]
    v_pk_mul_f32 v[90:91], v[90:91], v[66:67]
    v_pk_mul_f32 v[92:93], v[92:93], v[68:69]
    v_pk_mul_f32 v[94:95], v[94:95], v[70:71]
    v_exp_f32 v88, v88
    v_exp_f32 v89, v89
    v_exp_f32 v90, v90
    v_exp_f32 v91, v91
    v_exp_f32 v92, v92
    v_exp_f32 v93, v93
    v_exp_f32 v94, v94
    v_exp_f32 v95, v95
    v_pk_fma_f32 v[88:89], v[88:89], v[112:113], v[112:113] op_sel_hi:[1,0,0]
    v_pk_fma_f32 v[90:91], v[90:91], v[112:113], v[112:113] op_sel_hi:[1,0,0]
    v_pk_fma_f32 v[92:93], v[92:93], v[112:113], v[112:113] op_sel_hi:[1,0,0]
    v_pk_fma_f32 v[94:95], v[94:95], v[112:113], v[112:113] op_sel_hi:[1,0,0]
    v_rcp_f32 v88, v88
    v_rcp_f32 v89, v89
    v_rcp_f32 v90, v90
    v_rcp_f32 v91, v91
    v_rcp_f32 v92, v92
    v_rcp_f32 v93, v93
    v_rcp_f32 v94, v94
    v_rcp_f32 v95, v95
    v_pk_mul_f32 v[64:65], v[64:65], v[88:89]
    v_pk_mul_f32 v[66:67], v[66:67], v[90:91]
    v_pk_mul_f32 v[68:69], v[68:69], v[92:93]
    v_pk_mul_f32 v[70:71], v[70:71], v[94:95]
    v_cvt_pk_bf16_f32 v56, v64, v65
    v_cvt_pk_bf16_f32 v57, v66, v67
    v_cvt_pk_bf16_f32 v58, v68, v69
    v_cvt_pk_bf16_f32 v59, v70, v71
    buffer_store_dwordx4 v[56:59], v4, s[20:23], s33 offen offset:0 sc1
    v_pk_mul_f32 v[88:89], v[72:73], v[72:73]
    v_pk_mul_f32 v[90:91], v[74:75], v[74:75]
    v_pk_mul_f32 v[92:93], v[76:77], v[76:77]
    v_pk_mul_f32 v[94:95], v[78:79], v[78:79]
    v_pk_fma_f32 v[88:89], v[88:89], v[142:143], v[140:141] op_sel_hi:[1,0,0]
    v_pk_fma_f32 v[90:91], v[90:91], v[142:143], v[140:141] op_sel_hi:[1,0,0]
    v_pk_fma_f32 v[92:93], v[92:93], v[142:143], v[140:141] op_sel_hi:[1,0,0]
    v_pk_fma_f32 v[94:95], v[94:95], v[142:143], v[140:141] op_sel_hi:[1,0,0]
    v_pk_mul_f32 v[88:89], v[88:89], v[72:73]
    v_pk_mul_f32 v[90:91], v[90:91], v[74:75]
    v_pk_mul_f32 v[92:93], v[92:93], v[76:77]
    v_pk_mul_f32 v[94:95], v[94:95], v[78:79]
    v_exp_f32 v88, v88
    v_exp_f32 v89, v89
    v_exp_f32 v90, v90
    v_exp_f32 v91, v91
    v_exp_f32 v92, v92
    v_exp_f32 v93, v93
    v_exp_f32 v94, v94
    v_exp_f32 v95, v95
    v_pk_fma_f32 v[88:89], v[88:89], v[112:113], v[112:113] op_sel_hi:[1,0,0]
    v_pk_fma_f32 v[90:91], v[90:91], v[112:113], v[112:113] op_sel_hi:[1,0,0]
    v_pk_fma_f32 v[92:93], v[92:93], v[112:113], v[112:113] op_sel_hi:[1,0,0]
    v_pk_fma_f32 v[94:95], v[94:95], v[112:113], v[112:113] op_sel_hi:[1,0,0]
    v_rcp_f32 v88, v88
    v_rcp_f32 v89, v89
    v_rcp_f32 v90, v90
    v_rcp_f32 v91, v91
    v_rcp_f32 v92, v92
    v_rcp_f32 v93, v93
    v_rcp_f32 v94, v94
    v_rcp_f32 v95, v95
    v_pk_mul_f32 v[72:73], v[72:73], v[88:89]
    v_pk_mul_f32 v[74:75], v[74:75], v[90:91]
    v_pk_mul_f32 v[76:77], v[76:77], v[92:93]
    v_pk_mul_f32 v[78:79], v[78:79], v[94:95]
    v_cvt_pk_bf16_f32 v60, v72, v73
    v_cvt_pk_bf16_f32 v61, v74, v75
    v_cvt_pk_bf16_f32 v62, v76, v77
    v_cvt_pk_bf16_f32 v63, v78, v79
    buffer_store_dwordx4 v[60:63], v4, s[20:23], s33 offen offset:1024 sc1
    s_mov_b32 s50, 0
    s_waitcnt vmcnt(4)
F_gretry:
    v_xor_b32 v12, v145, v106
    v_xor_b32 v13, v147, v107
    v_or_b32 v12, v12, v13
    v_xor_b32 v13, v149, v106
    v_xor_b32 v14, v151, v107
    v_or3_b32 v12, v12, v13, v14
    v_xor_b32 v13, v153, v106
    v_xor_b32 v14, v155, v107
    v_or3_b32 v12, v12, v13, v14
    v_xor_b32 v13, v157, v106
    v_xor_b32 v14, v159, v107
    v_or3_b32 v12, v12, v13, v14
    v_xor_b32 v13, v161, v106
    v_xor_b32 v14, v163, v107
    v_or3_b32 v12, v12, v13, v14
    v_xor_b32 v13, v165, v106
    v_xor_b32 v14, v167, v107
    v_or3_b32 v12, v12, v13, v14
    v_xor_b32 v13, v169, v106
    v_xor_b32 v14, v171, v107
    v_or3_b32 v12, v12, v13, v14
    v_cmp_ne_u32 vcc, 0, v12
    s_nop 1
    s_cbranch_vccz F_gok
    s_add_u32 s50, s50, 1
    s_cmp_gt_u32 s50, 0x100000
    s_cbranch_scc1 F_gok
    s_sleep 1
    buffer_load_dwordx4 v[144:147], v15, s[20:23], s42 offen offset:0 sc1
    buffer_load_dwordx4 v[148:151], v15, s[20:23], s42 offen offset:512 sc1
    buffer_load_dwordx4 v[152:155], v15, s[20:23], s42 offen offset:1024 sc1
    buffer_load_dwordx4 v[156:159], v15, s[20:23], s42 offen offset:1536 sc1
    buffer_load_dwordx4 v[160:163], v15, s[20:23], s42 offen offset:2048 sc1
    buffer_load_dwordx4 v[164:167], v15, s[20:23], s42 offen offset:2560 sc1
    buffer_load_dwordx4 v[168:171], v15, s[20:23], s42 offen offset:3072 sc1
    s_waitcnt vmcnt(0)
    s_branch F_gretry
F_gok:
    v_add_f32 v144, v144, v148
    v_add_f32 v152, v152, v156
    v_add_f32 v160, v160, v164
    v_add_f32 v146, v146, v150
    v_add_f32 v154, v154, v158
    v_add_f32 v162, v162, v166
    v_add_f32 v144, v144, v152
    v_add_f32 v160, v160, v168
    v_add_f32 v146, v146, v154
    v_add_f32 v162, v162, v170
    v_add_f32 v144, v144, v160
    v_add_f32 v146, v146, v162
    v_mov_b32 v13, v144
    s_nop 1
    v_permlane32_swap_b32 v144, v13
    v_add_f32 v144, v144, v13
    v_mov_b32 v14, v146
    s_nop 1
    v_permlane32_swap_b32 v146, v14
    v_add_f32 v146, v146, v14
    v_mul_f32 v144, 0x3a924925, v144
    v_mul_f32 v146, 0x3a924925, v146
    v_fma_f32 v13, -v144, v144, v146
    v_max_f32 v13, 0, v13
    v_cvt_pk_bf16_f32 v140, v144, v144
    v_and_b32 v140, 0xffff0000, v140
    v_cvt_pk_bf16_f32 v13, v13, v13
    v_and_b32 v13, 0xffff0000, v13
    v_add_f32 v13, 0x3727c5ac, v13
    v_cvt_pk_bf16_f32 v13, v13, v13
    v_and_b32 v13, 0xffff0000, v13
    v_sqrt_f32 v13, v13
    s_nop 0
    v_cvt_pk_bf16_f32 v13, v13, v13
    v_and_b32 v13, 0xffff0000, v13
    v_rcp_f32 v142, v13
    s_nop 0
    v_mul_f32 v140, v140, v142
    v_sub_f32 v140, 0, v140
    s_lshl_b32 s32, s26, 8
    s_lshl_b32 s33, s34, 1
    s_add_u32 s32, s32, s33
    s_lshl_b32 s32, s32, 10
    s_add_u32 s32, s32, 4194304
    s_add_u32 s33, s32, 131072
    v_pk_fma_f32 v[16:17], v[16:17], v[142:143], v[140:141] op_sel_hi:[1,0,0]
    v_pk_fma_f32 v[18:19], v[18:19], v[142:143], v[140:141] op_sel_hi:[1,0,0]
    v_pk_fma_f32 v[20:21], v[20:21], v[142:143], v[140:141] op_sel_hi:[1,0,0]
    v_pk_fma_f32 v[22:23], v[22:23], v[142:143], v[140:141] op_sel_hi:[1,0,0]
    v_pk_fma_f32 v[24:25], v[24:25], v[142:143], v[140:141] op_sel_hi:[1,0,0]
    v_pk_fma_f32 v[26:27], v[26:27], v[142:143], v[140:141] op_sel_hi:[1,0,0]
    v_pk_fma_f32 v[28:29], v[28:29], v[142:143], v[140:141] op_sel_hi:[1,0,0]
    v_pk_fma_f32 v[30:31], v[30:31], v[142:143], v[140:141] op_sel_hi:[1,0,0]
    v_cvt_pk_bf16_f32 v64, v16, v17
    v_cvt_pk_bf16_f32 v65, v18, v19
    ds_write_b64 v128, v[64:65]
    v_cvt_pk_bf16_f32 v66, v20, v21
    v_cvt_pk_bf16_f32 v67, v22, v23
    ds_write_b64 v129, v[66:67]
    v_cvt_pk_bf16_f32 v68, v24, v25
    v_cvt_pk_bf16_f32 v69, v26, v27
    ds_write_b64 v130, v[68:69]
    v_cvt_pk_bf16_f32 v70, v28, v29
    v_cvt_pk_bf16_f32 v71, v30, v31
    ds_write_b64 v131, v[70:71]
    ds_read_b64_tr_b16 v[48:49], v136 offset:0
    ds_read_b64_tr_b16 v[50:51], v137 offset:256
    ds_read_b64_tr_b16 v[52:53], v136 offset:1024
    ds_read_b64_tr_b16 v[54:55], v137 offset:1280
    v_pk_fma_f32 v[32:33], v[32:33], v[142:143], v[140:141] op_sel_hi:[1,0,0]
    v_pk_fma_f32 v[34:35], v[34:35], v[142:143], v[140:141] op_sel_hi:[1,0,0]
    v_pk_fma_f32 v[36:37], v[36:37], v[142:143], v[140:141] op_sel_hi:[1,0,0]
    v_pk_fma_f32 v[38:39], v[38:39], v[142:143], v[140:141] op_sel_hi:[1,0,0]
    v_pk_fma_f32 v[40:41], v[40:41], v[142:143], v[140:141] op_sel_hi:[1,0,0]
    v_pk_fma_f32 v[42:43], v[42:43], v[142:143], v[140:141] op_sel_hi:[1,0,0]
    v_pk_fma_f32 v[44:45], v[44:45], v[142:143], v[140:141] op_sel_hi:[1,0,0]
    v_pk_fma_f32 v[46:47], v[46:47], v[142:143], v[140:141] op_sel_hi:[1,0,0]
    v_cvt_pk_bf16_f32 v72, v32, v33
    v_cvt_pk_bf16_f32 v73, v34, v35
    ds_write_b64 v128, v[72:73]
    v_cvt_pk_bf16_f32 v74, v36, v37
    v_cvt_pk_bf16_f32 v75, v38, v39
    ds_write_b64 v129, v[74:75]
    v_cvt_pk_bf16_f32 v76, v40, v41
    v_cvt_pk_bf16_f32 v77, v42, v43
    ds_write_b64 v130, v[76:77]
    v_cvt_pk_bf16_f32 v78, v44, v45
    v_cvt_pk_bf16_f32 v79, v46, v47
    ds_write_b64 v131, v[78:79]
    ds_read_b64_tr_b16 v[56:57], v136 offset:0
    ds_read_b64_tr_b16 v[58:59], v137 offset:256
    ds_read_b64_tr_b16 v[60:61], v136 offset:1024
    ds_read_b64_tr_b16 v[62:63], v137 offset:1280
    s_cmp_lg_u32 s26, 0
    s_cbranch_scc1 F_noxst
    v_and_b32 v11, 31, v1
    v_lshlrev_b32 v11, 3, v11
    s_lshl_b32 s43, s34, 8
    s_add_u32 s43, s43, 22020096
    buffer_store_dwordx2 v[114:115], v11, s[20:23], s43 offen sc1
F_noxst:
    s_waitcnt lgkmcnt(10)
    buffer_store_dwordx4 v[48:51], v4, s[20:23], s32 offen offset:0 sc1
    s_waitcnt lgkmcnt(8)
    buffer_store_dwordx4 v[52:55], v4, s[20:23], s32 offen offset:1024 sc1
    s_waitcnt lgkmcnt(2)
    buffer_store_dwordx4 v[56:59], v4, s[20:23], s33 offen offset:0 sc1
    s_waitcnt lgkmcnt(0)
    buffer_store_dwordx4 v[60:63], v4, s[20:23], s33 offen offset:1024 sc1
    v_mov_b32 v94, v106
    v_mov_b32 v95, v107
    s_lshl_b32 s45, s26, 6
    s_add_u32 s45, s45, s34
    s_lshl_b32 s45, s45, 6
    s_add_u32 s45, s45, 21495808
    s_and_b32 s32, s28, 1
    s_mul_i32 s32, s32, 28
    s_add_u32 s32, s32, s29
    s_lshr_b32 s25, s32, 3
    s_and_b32 s32, s32, 7
    s_lshr_b32 s26, s28, 1
    s_lshl_b32 s26, s26, 3
    s_add_u32 s26, s26, s32
    s_lshl_b32 s27, s25, 2
    s_add_u32 s27, s27, s24
    v_lshrrev_b32 v11, 3, v1
    v_and_b32 v12, 7, v1
    v_lshrrev_b32 v13, 4, v1
    v_lshlrev_b32 v14, 12, v11
    v_xor_b32 v15, v12, v13
    v_lshl_add_u32 v2, v15, 4, v14
    v_xor_b32 v15, 4, v15
    v_lshl_add_u32 v3, v15, 4, v14
    v_add_u32 v3, 0x8000, v3
    s_lshl_b32 s34, s26, 2
    s_add_u32 s34, s34, s24
    s_lshl_b32 s34, s34, 16
    s_lshl_b32 s35, s27, 17
    s_add_u32 s35, s35, 4194304
    s_lshl_b32 s36, s24, 11
    s_mov_b32 s12, s64
    s_and_b32 s13, s65, 0xffff
    s_mov_b32 s14, 8388608
    s_mov_b32 s15, 0x20000
    s_mov_b32 s16, s66
    s_and_b32 s17, s67, 0xffff
    s_mov_b32 s18, 4096
    s_mov_b32 s19, 0x20000
    v_and_b32 v11, 31, v1
    v_lshrrev_b32 v12, 5, v1
    v_bfe_u32 v13, v1, 1, 3
    v_xor_b32 v13, v13, v12
    v_lshlrev_b32 v14, 7, v11
    v_lshl_add_u32 v5, v13, 4, v14
    v_xor_b32 v6, 32, v5
    v_xor_b32 v7, 64, v5
    v_xor_b32 v8, 96, v5
    v_lshlrev_b32 v11, 1, v11
    s_lshl_b32 s40, s27, 6
    s_lshl_b32 s37, s26, 1
    s_add_u32 s40, s40, s37
    s_lshl_b32 s40, s40, 11
    s_lshl_b32 s41, s26, 7
    s_lshl_b32 s44, s25, 13
    s_add_u32 s44, s44, 21495808
    s_add_u32 s46, s44, 4096
    v_lshlrev_b32 v9, 6, v1
    v_mov_b32 v10, 0
    s_waitcnt vmcnt(0)
    s_mov_b64 exec, 1
    buffer_store_dwordx2 v[94:95], v10, s[20:23], s45 offen sc1
    s_mov_b64 exec, -1
    s_lshl_b32 s32, s24, 2
    s_add_u32 s32, s32, 157712
    v_mov_b32 v12, s32
    s_mov_b32 s47, 0
F_ugp:
    ds_read_b32 v13, v12
    s_waitcnt lgkmcnt(0)
    v_cmp_ne_u32 vcc, 1, v13
    s_nop 1
    s_cbranch_vccz F_ugok
    s_add_u32 s47, s47, 1
    s_sleep 1
    s_cmp_gt_u32 s47, 0x400000
    s_cbranch_scc0 F_ugp
F_ugok:
    s_add_u32 m0, s36, 114688
    s_add_u32 s38, s34, 0
    buffer_load_dwordx4 v2, s[12:15], s38 offen lds
    s_add_u32 m0, s36, 115712
    s_nop 0
    buffer_load_dwordx4 v3, s[12:15], s38 offen lds
    s_add_u32 m0, s36, 122880
    s_add_u32 s38, s34, 128
    buffer_load_dwordx4 v2, s[12:15], s38 offen lds
    s_add_u32 m0, s36, 123904
    s_nop 0
    buffer_load_dwordx4 v3, s[12:15], s38 offen lds
    s_add_u32 m0, s36, 131072
    s_add_u32 s38, s34, 256
    buffer_load_dwordx4 v2, s[12:15], s38 offen lds
    s_add_u32 m0, s36, 132096
    s_nop 0
    buffer_load_dwordx4 v3, s[12:15], s38 offen lds
    s_add_u32 m0, s36, 139264
    s_add_u32 s38, s34, 384
    buffer_load_dwordx4 v2, s[12:15], s38 offen lds
    s_add_u32 m0, s36, 140288
    s_nop 0
    buffer_load_dwordx4 v3, s[12:15], s38 offen lds
    s_add_u32 m0, s36, 147456
    s_add_u32 s38, s34, 512
    buffer_load_dwordx4 v2, s[12:15], s38 offen lds
    s_add_u32 m0, s36, 148480
    s_nop 0
    buffer_load_dwordx4 v3, s[12:15], s38 offen lds
    s_add_u32 m0, s36, 0
    s_add_u32 s38, s34, 640
    buffer_load_dwordx4 v2, s[12:15], s38 offen lds
    s_add_u32 m0, s36, 1024
    s_nop 0
    buffer_load_dwordx4 v3, s[12:15], s38 offen lds
    s_add_u32 m0, s36, 8192
    s_add_u32 s38, s34, 768
    buffer_load_dwordx4 v2, s[12:15], s38 offen lds
    s_add_u32 m0, s36, 9216
    s_nop 0
    buffer_load_dwordx4 v3, s[12:15], s38 offen lds
    s_add_u32 m0, s36, 16384
    s_add_u32 s38, s34, 896
    buffer_load_dwordx4 v2, s[12:15], s38 offen lds
    s_add_u32 m0, s36, 17408
    s_nop 0
    buffer_load_dwordx4 v3, s[12:15], s38 offen lds
    s_add_u32 m0, s36, 24576
    s_add_u32 s38, s34, 1024
    buffer_load_dwordx4 v2, s[12:15], s38 offen lds
    s_add_u32 m0, s36, 25600
    s_nop 0
    buffer_load_dwordx4 v3, s[12:15], s38 offen lds
    s_add_u32 m0, s36, 32768
    s_add_u32 s38, s34, 1152
    buffer_load_dwordx4 v2, s[12:15], s38 offen lds
    s_add_u32 m0, s36, 33792
    s_nop 0
    buffer_load_dwordx4 v3, s[12:15], s38 offen lds
    s_add_u32 m0, s36, 40960
    s_add_u32 s38, s34, 1280
    buffer_load_dwordx4 v2, s[12:15], s38 offen lds
    s_add_u32 m0, s36, 41984
    s_nop 0
    buffer_load_dwordx4 v3, s[12:15], s38 offen lds
    s_add_u32 s38, s34, 1408
    buffer_load_dwordx4 v[152:155], v2, s[12:15], s38 offen
    buffer_load_dwordx4 v[156:159], v3, s[12:15], s38 offen
    s_add_u32 s38, s34, 1536
    buffer_load_dwordx4 v[160:163], v2, s[12:15], s38 offen
    buffer_load_dwordx4 v[164:167], v3, s[12:15], s38 offen
    s_add_u32 s38, s34, 1664
    buffer_load_dwordx4 v[168:171], v2, s[12:15], s38 offen
    buffer_load_dwordx4 v[172:175], v3, s[12:15], s38 offen
    s_add_u32 s38, s34, 1792
    buffer_load_dwordx4 v[176:179], v2, s[12:15], s38 offen
    buffer_load_dwordx4 v[180:183], v3, s[12:15], s38 offen
    s_add_u32 s38, s34, 1920
    buffer_load_dwordx4 v[184:187], v2, s[12:15], s38 offen
    buffer_load_dwordx4 v[188:191], v3, s[12:15], s38 offen
    s_add_u32 s38, s34, 2048
    buffer_load_dwordx4 v[192:195], v2, s[12:15], s38 offen
    buffer_load_dwordx4 v[196:199], v3, s[12:15], s38 offen
    s_add_u32 s38, s34, 2176
    buffer_load_dwordx4 v[200:203], v2, s[12:15], s38 offen
    buffer_load_dwordx4 v[204:207], v3, s[12:15], s38 offen
    s_add_u32 s38, s34, 2304
    buffer_load_dwordx4 v[208:211], v2, s[12:15], s38 offen
    buffer_load_dwordx4 v[212:215], v3, s[12:15], s38 offen
    s_add_u32 s38, s34, 2432
    buffer_load_dwordx4 v[216:219], v2, s[12:15], s38 offen
    buffer_load_dwordx4 v[220:223], v3, s[12:15], s38 offen
    s_add_u32 s38, s34, 2560
    buffer_load_dwordx4 v[224:227], v2, s[12:15], s38 offen
    buffer_load_dwordx4 v[228:231], v3, s[12:15], s38 offen
    s_add_u32 s38, s34, 2688
    buffer_load_dwordx4 v[232:235], v2, s[12:15], s38 offen
    buffer_load_dwordx4 v[236:239], v3, s[12:15], s38 offen
    s_add_u32 s38, s34, 2816
    buffer_load_dwordx4 v[240:243], v2, s[12:15], s38 offen
    buffer_load_dwordx4 v[244:247], v3, s[12:15], s38 offen
    s_add_u32 s38, s34, 2944
    buffer_load_dwordx4 v[248:251], v2, s[12:15], s38 offen
    buffer_load_dwordx4 v[252:255], v3, s[12:15], s38 offen
    v_add_u32 v92, s36, v4
    v_add_u32 v93, 114688, v92
    s_waitcnt vmcnt(40)
    s_barrier
    s_add_u32 s33, s35, 0
    buffer_load_dwordx4 v[96:99], v4, s[20:23], s33 offen offset:0 sc1
    buffer_load_dwordx4 v[100:103], v4, s[20:23], s33 offen offset:1024 sc1
    buffer_load_dwordx4 v[104:107], v4, s[20:23], s33 offen offset:2048 sc1
    buffer_load_dwordx4 v[108:111], v4, s[20:23], s33 offen offset:3072 sc1
    s_add_u32 s33, s35, 4096
    buffer_load_dwordx4 v[112:115], v4, s[20:23], s33 offen offset:0 sc1
    buffer_load_dwordx4 v[116:119], v4, s[20:23], s33 offen offset:1024 sc1
    buffer_load_dwordx4 v[120:123], v4, s[20:23], s33 offen offset:2048 sc1
    buffer_load_dwordx4 v[124:127], v4, s[20:23], s33 offen offset:3072 sc1
    s_add_u32 s33, s35, 8192
    buffer_load_dwordx4 v[128:131], v4, s[20:23], s33 offen offset:0 sc1
    buffer_load_dwordx4 v[132:135], v4, s[20:23], s33 offen offset:1024 sc1
    buffer_load_dwordx4 v[136:139], v4, s[20:23], s33 offen offset:2048 sc1
    buffer_load_dwordx4 v[140:143], v4, s[20:23], s33 offen offset:3072 sc1
    s_add_u32 s33, s35, 12288
    buffer_load_dwordx4 v[144:147], v4, s[20:23], s33 offen offset:0 sc1
    v_add_u32 v12, 114688, v5
    v_add_u32 v13, 114688, v6
    v_add_u32 v14, 114688, v7
    v_add_u32 v15, 114688, v8
    ds_read_b128 v[48:51], v12 offset:0
    ds_read_b128 v[52:55], v12 offset:4096
    ds_read_b128 v[56:59], v13 offset:0
    ds_read_b128 v[60:63], v13 offset:4096
    s_waitcnt vmcnt(12) lgkmcnt(2)
    v_mfma_f32_32x32x16_bf16 v[16:31], v[96:99], v[48:51], 0
    ds_read_b128 v[64:67], v14 offset:0
    ds_read_b128 v[68:71], v14 offset:4096
    v_mfma_f32_32x32x16_bf16 v[32:47], v[96:99], v[52:55], 0
    buffer_load_dwordx4 v[148:151], v4, s[20:23], s33 offen offset:1024 sc1
    s_waitcnt vmcnt(12) lgkmcnt(2)
    v_mfma_f32_32x32x16_bf16 v[16:31], v[100:103], v[56:59], v[16:31]
    ds_read_b128 v[48:51], v15 offset:0
    ds_read_b128 v[52:55], v15 offset:4096
    v_mfma_f32_32x32x16_bf16 v[32:47], v[100:103], v[60:63], v[32:47]
    buffer_load_dwordx4 v[96:99], v4, s[20:23], s33 offen offset:2048 sc1
    s_waitcnt vmcnt(12) lgkmcnt(2)
    v_mfma_f32_32x32x16_bf16 v[16:31], v[104:107], v[64:67], v[16:31]
    ds_read_b128 v[56:59], v12 offset:8192
    ds_read_b128 v[60:63], v12 offset:12288
    v_mfma_f32_32x32x16_bf16 v[32:47], v[104:107], v[68:71], v[32:47]
    buffer_load_dwordx4 v[100:103], v4, s[20:23], s33 offen offset:3072 sc1
    s_waitcnt vmcnt(12) lgkmcnt(2)
    v_mfma_f32_32x32x16_bf16 v[16:31], v[108:111], v[48:51], v[16:31]
    ds_read_b128 v[64:67], v13 offset:8192
    ds_read_b128 v[68:71], v13 offset:12288
    v_mfma_f32_32x32x16_bf16 v[32:47], v[108:111], v[52:55], v[32:47]
    s_add_u32 s33, s35, 16384
    buffer_load_dwordx4 v[104:107], v4, s[20:23], s33 offen offset:0 sc1
    s_waitcnt vmcnt(12) lgkmcnt(2)
    v_mfma_f32_32x32x16_bf16 v[16:31], v[112:115], v[56:59], v[16:31]
    ds_read_b128 v[48:51], v14 offset:8192
    ds_read_b128 v[52:55], v14 offset:12288
    v_mfma_f32_32x32x16_bf16 v[32:47], v[112:115], v[60:63], v[32:47]
    buffer_load_dwordx4 v[108:111], v4, s[20:23], s33 offen offset:1024 sc1
    s_waitcnt vmcnt(12) lgkmcnt(2)
    v_mfma_f32_32x32x16_bf16 v[16:31], v[116:119], v[64:67], v[16:31]
    ds_read_b128 v[56:59], v15 offset:8192
    ds_read_b128 v[60:63], v15 offset:12288
    v_mfma_f32_32x32x16_bf16 v[32:47], v[116:119], v[68:71], v[32:47]
    buffer_load_dwordx4 v[112:115], v4, s[20:23], s33 offen offset:2048 sc1
    s_waitcnt vmcnt(12) lgkmcnt(2)
    v_mfma_f32_32x32x16_bf16 v[16:31], v[120:123], v[48:51], v[16:31]
    ds_read_b128 v[64:67], v12 offset:16384
    ds_read_b128 v[68:71], v12 offset:20480
    v_mfma_f32_32x32x16_bf16 v[32:47], v[120:123], v[52:55], v[32:47]
    buffer_load_dwordx4 v[116:119], v4, s[20:23], s33 offen offset:3072 sc1
    s_waitcnt vmcnt(12) lgkmcnt(2)
    v_mfma_f32_32x32x16_bf16 v[16:31], v[124:127], v[56:59], v[16:31]
    ds_read_b128 v[48:51], v13 offset:16384
    ds_read_b128 v[52:55], v13 offset:20480
    v_mfma_f32_32x32x16_bf16 v[32:47], v[124:127], v[60:63], v[32:47]
    s_add_u32 s33, s35, 20480
    buffer_load_dwordx4 v[120:123], v4, s[20:23], s33 offen offset:0 sc1
    s_waitcnt vmcnt(12) lgkmcnt(2)
    v_mfma_f32_32x32x16_bf16 v[16:31], v[128:131], v[64:67], v[16:31]
    ds_read_b128 v[56:59], v14 offset:16384
    ds_read_b128 v[60:63], v14 offset:20480
    v_mfma_f32_32x32x16_bf16 v[32:47], v[128:131], v[68:71], v[32:47]
    buffer_load_dwordx4 v[124:127], v4, s[20:23], s33 offen offset:1024 sc1
    s_waitcnt vmcnt(12) lgkmcnt(2)
    v_mfma_f32_32x32x16_bf16 v[16:31], v[132:135], v[48:51], v[16:31]
    ds_read_b128 v[64:67], v15 offset:16384
    ds_read_b128 v[68:71], v15 offset:20480
    v_mfma_f32_32x32x16_bf16 v[32:47], v[132:135], v[52:55], v[32:47]
    buffer_load_dwordx4 v[128:131], v4, s[20:23], s33 offen offset:2048 sc1
    s_waitcnt vmcnt(12) lgkmcnt(2)
    v_mfma_f32_32x32x16_bf16 v[16:31], v[136:139], v[56:59], v[16:31]
    ds_read_b128 v[48:51], v12 offset:24576
    ds_read_b128 v[52:55], v12 offset:28672
    v_mfma_f32_32x32x16_bf16 v[32:47], v[136:139], v[60:63], v[32:47]
    buffer_load_dwordx4 v[132:135], v4, s[20:23], s33 offen offset:3072 sc1
    s_waitcnt vmcnt(12) lgkmcnt(2)
    v_mfma_f32_32x32x16_bf16 v[16:31], v[140:143], v[64:67], v[16:31]
    ds_read_b128 v[56:59], v13 offset:24576
    ds_read_b128 v[60:63], v13 offset:28672
    v_mfma_f32_32x32x16_bf16 v[32:47], v[140:143], v[68:71], v[32:47]
    s_add_u32 s33, s35, 24576
    buffer_load_dwordx4 v[136:139], v4, s[20:23], s33 offen offset:0 sc1
    s_waitcnt vmcnt(12) lgkmcnt(2)
    v_mfma_f32_32x32x16_bf16 v[16:31], v[144:147], v[48:51], v[16:31]
    ds_read_b128 v[64:67], v14 offset:24576
    ds_read_b128 v[68:71], v14 offset:28672
    v_mfma_f32_32x32x16_bf16 v[32:47], v[144:147], v[52:55], v[32:47]
    buffer_load_dwordx4 v[140:143], v4, s[20:23], s33 offen offset:1024 sc1
    s_waitcnt vmcnt(12) lgkmcnt(2)
    v_mfma_f32_32x32x16_bf16 v[16:31], v[148:151], v[56:59], v[16:31]
    ds_read_b128 v[48:51], v15 offset:24576
    ds_read_b128 v[52:55], v15 offset:28672
    v_mfma_f32_32x32x16_bf16 v[32:47], v[148:151], v[60:63], v[32:47]
    buffer_load_dwordx4 v[144:147], v4, s[20:23], s33 offen offset:2048 sc1
    s_waitcnt vmcnt(12) lgkmcnt(2)
    v_mfma_f32_32x32x16_bf16 v[16:31], v[96:99], v[64:67], v[16:31]
    s_waitcnt vmcnt(59)
    s_barrier
    ds_read_b128 v[56:59], v12 offset:32768
    ds_read_b128 v[60:63], v12 offset:36864
    v_mfma_f32_32x32x16_bf16 v[32:47], v[96:99], v[68:71], v[32:47]
    buffer_load_dwordx4 v[148:151], v4, s[20:23], s33 offen offset:3072 sc1
    s_waitcnt vmcnt(12) lgkmcnt(2)
    v_mfma_f32_32x32x16_bf16 v[16:31], v[100:103], v[48:51], v[16:31]
    ds_read_b128 v[64:67], v13 offset:32768
    ds_read_b128 v[68:71], v13 offset:36864
    v_mfma_f32_32x32x16_bf16 v[32:47], v[100:103], v[52:55], v[32:47]
    s_add_u32 s33, s35, 28672
    buffer_load_dwordx4 v[96:99], v4, s[20:23], s33 offen offset:0 sc1
    s_waitcnt vmcnt(12) lgkmcnt(2)
    v_mfma_f32_32x32x16_bf16 v[16:31], v[104:107], v[56:59], v[16:31]
    ds_read_b128 v[48:51], v14 offset:32768
    ds_read_b128 v[52:55], v14 offset:36864
    v_mfma_f32_32x32x16_bf16 v[32:47], v[104:107], v[60:63], v[32:47]
    buffer_load_dwordx4 v[100:103], v4, s[20:23], s33 offen offset:1024 sc1
    s_waitcnt vmcnt(12) lgkmcnt(2)
    v_mfma_f32_32x32x16_bf16 v[16:31], v[108:111], v[64:67], v[16:31]
    ds_read_b128 v[56:59], v15 offset:32768
    ds_read_b128 v[60:63], v15 offset:36864
    v_mfma_f32_32x32x16_bf16 v[32:47], v[108:111], v[68:71], v[32:47]
    buffer_load_dwordx4 v[104:107], v4, s[20:23], s33 offen offset:2048 sc1
    s_waitcnt vmcnt(12) lgkmcnt(2)
    v_mfma_f32_32x32x16_bf16 v[16:31], v[112:115], v[48:51], v[16:31]
    ds_read_b128 v[64:67], v5 offset:0
    ds_read_b128 v[68:71], v5 offset:4096
    v_mfma_f32_32x32x16_bf16 v[32:47], v[112:115], v[52:55], v[32:47]
    buffer_load_dwordx4 v[108:111], v4, s[20:23], s33 offen offset:3072 sc1
    s_waitcnt vmcnt(12) lgkmcnt(2)
    v_mfma_f32_32x32x16_bf16 v[16:31], v[116:119], v[56:59], v[16:31]
    ds_read_b128 v[48:51], v6 offset:0
    ds_read_b128 v[52:55], v6 offset:4096
    v_mfma_f32_32x32x16_bf16 v[32:47], v[116:119], v[60:63], v[32:47]
    s_add_u32 s33, s35, 32768
    buffer_load_dwordx4 v[112:115], v4, s[20:23], s33 offen offset:0 sc1
    s_waitcnt vmcnt(12) lgkmcnt(2)
    v_mfma_f32_32x32x16_bf16 v[16:31], v[120:123], v[64:67], v[16:31]
    ds_read_b128 v[56:59], v7 offset:0
    ds_read_b128 v[60:63], v7 offset:4096
    v_mfma_f32_32x32x16_bf16 v[32:47], v[120:123], v[68:71], v[32:47]
    buffer_load_dwordx4 v[116:119], v4, s[20:23], s33 offen offset:1024 sc1
    s_waitcnt vmcnt(12) lgkmcnt(2)
    v_mfma_f32_32x32x16_bf16 v[16:31], v[124:127], v[48:51], v[16:31]
    ds_read_b128 v[64:67], v8 offset:0
    ds_read_b128 v[68:71], v8 offset:4096
    v_mfma_f32_32x32x16_bf16 v[32:47], v[124:127], v[52:55], v[32:47]
    buffer_load_dwordx4 v[120:123], v4, s[20:23], s33 offen offset:2048 sc1
    s_waitcnt vmcnt(12) lgkmcnt(2)
    v_mfma_f32_32x32x16_bf16 v[16:31], v[128:131], v[56:59], v[16:31]
    ds_read_b128 v[48:51], v5 offset:8192
    ds_read_b128 v[52:55], v5 offset:12288
    v_mfma_f32_32x32x16_bf16 v[32:47], v[128:131], v[60:63], v[32:47]
    s_waitcnt vmcnt(59)
    ds_write_b128 v93, v[152:155] offset:0
    buffer_load_dwordx4 v[124:127], v4, s[20:23], s33 offen offset:3072 sc1
    s_waitcnt vmcnt(12) lgkmcnt(3)
    v_mfma_f32_32x32x16_bf16 v[16:31], v[132:135], v[64:67], v[16:31]
    ds_read_b128 v[56:59], v6 offset:8192
    ds_read_b128 v[60:63], v6 offset:12288
    v_mfma_f32_32x32x16_bf16 v[32:47], v[132:135], v[68:71], v[32:47]
    ds_write_b128 v93, v[156:159] offset:1024
    s_add_u32 s33, s35, 36864
    buffer_load_dwordx4 v[128:131], v4, s[20:23], s33 offen offset:0 sc1
    s_waitcnt vmcnt(12) lgkmcnt(4)
    v_mfma_f32_32x32x16_bf16 v[16:31], v[136:139], v[48:51], v[16:31]
    ds_read_b128 v[64:67], v7 offset:8192
    ds_read_b128 v[68:71], v7 offset:12288
    v_mfma_f32_32x32x16_bf16 v[32:47], v[136:139], v[52:55], v[32:47]
    buffer_load_dwordx4 v[132:135], v4, s[20:23], s33 offen offset:1024 sc1
    s_waitcnt vmcnt(12) lgkmcnt(3)
    v_mfma_f32_32x32x16_bf16 v[16:31], v[140:143], v[56:59], v[16:31]
    ds_read_b128 v[48:51], v8 offset:8192
    ds_read_b128 v[52:55], v8 offset:12288
    v_mfma_f32_32x32x16_bf16 v[32:47], v[140:143], v[60:63], v[32:47]
    buffer_load_dwordx4 v[136:139], v4, s[20:23], s33 offen offset:2048 sc1
    s_waitcnt vmcnt(12) lgkmcnt(2)
    v_mfma_f32_32x32x16_bf16 v[16:31], v[144:147], v[64:67], v[16:31]
    ds_read_b128 v[56:59], v5 offset:16384
    ds_read_b128 v[60:63], v5 offset:20480
    v_mfma_f32_32x32x16_bf16 v[32:47], v[144:147], v[68:71], v[32:47]
    buffer_load_dwordx4 v[140:143], v4, s[20:23], s33 offen offset:3072 sc1
    s_waitcnt vmcnt(12) lgkmcnt(2)
    v_mfma_f32_32x32x16_bf16 v[16:31], v[148:151], v[48:51], v[16:31]
    ds_read_b128 v[64:67], v6 offset:16384
    ds_read_b128 v[68:71], v6 offset:20480
    v_mfma_f32_32x32x16_bf16 v[32:47], v[148:151], v[52:55], v[32:47]
    s_add_u32 s33, s35, 40960
    buffer_load_dwordx4 v[144:147], v4, s[20:23], s33 offen offset:0 sc1
    s_waitcnt vmcnt(12) lgkmcnt(2)
    v_mfma_f32_32x32x16_bf16 v[16:31], v[96:99], v[56:59], v[16:31]
    ds_read_b128 v[48:51], v7 offset:16384
    ds_read_b128 v[52:55], v7 offset:20480
    v_mfma_f32_32x32x16_bf16 v[32:47], v[96:99], v[60:63], v[32:47]
    buffer_load_dwordx4 v[148:151], v4, s[20:23], s33 offen offset:1024 sc1
    s_waitcnt vmcnt(12) lgkmcnt(2)
    v_mfma_f32_32x32x16_bf16 v[16:31], v[100:103], v[64:67], v[16:31]
    ds_read_b128 v[56:59], v8 offset:16384
    ds_read_b128 v[60:63], v8 offset:20480
    v_mfma_f32_32x32x16_bf16 v[32:47], v[100:103], v[68:71], v[32:47]
    buffer_load_dwordx4 v[96:99], v4, s[20:23], s33 offen offset:2048 sc1
    s_waitcnt vmcnt(12) lgkmcnt(2)
    v_mfma_f32_32x32x16_bf16 v[16:31], v[104:107], v[48:51], v[16:31]
    s_waitcnt vmcnt(63) lgkmcnt(12)
    s_barrier
    ds_read_b128 v[64:67], v5 offset:24576
    ds_read_b128 v[68:71], v5 offset:28672
    v_mfma_f32_32x32x16_bf16 v[32:47], v[104:107], v[52:55], v[32:47]
    buffer_load_dwordx4 v[100:103], v4, s[20:23], s33 offen offset:3072 sc1
    s_waitcnt vmcnt(12) lgkmcnt(2)
    v_mfma_f32_32x32x16_bf16 v[16:31], v[108:111], v[56:59], v[16:31]
    ds_read_b128 v[48:51], v6 offset:24576
    ds_read_b128 v[52:55], v6 offset:28672
    v_mfma_f32_32x32x16_bf16 v[32:47], v[108:111], v[60:63], v[32:47]
    s_add_u32 s33, s35, 45056
    buffer_load_dwordx4 v[104:107], v4, s[20:23], s33 offen offset:0 sc1
    s_waitcnt vmcnt(12) lgkmcnt(2)
    v_mfma_f32_32x32x16_bf16 v[16:31], v[112:115], v[64:67], v[16:31]
    ds_read_b128 v[56:59], v7 offset:24576
    ds_read_b128 v[60:63], v7 offset:28672
    v_mfma_f32_32x32x16_bf16 v[32:47], v[112:115], v[68:71], v[32:47]
    ds_write_b128 v93, v[160:163] offset:8192
    buffer_load_dwordx4 v[108:111], v4, s[20:23], s33 offen offset:1024 sc1
    s_waitcnt vmcnt(12) lgkmcnt(3)
    v_mfma_f32_32x32x16_bf16 v[16:31], v[116:119], v[48:51], v[16:31]
    ds_read_b128 v[64:67], v8 offset:24576
    ds_read_b128 v[68:71], v8 offset:28672
    v_mfma_f32_32x32x16_bf16 v[32:47], v[116:119], v[52:55], v[32:47]
    ds_write_b128 v93, v[164:167] offset:9216
    buffer_load_dwordx4 v[112:115], v4, s[20:23], s33 offen offset:2048 sc1
    s_waitcnt vmcnt(12) lgkmcnt(4)
    v_mfma_f32_32x32x16_bf16 v[16:31], v[120:123], v[56:59], v[16:31]
    ds_read_b128 v[48:51], v5 offset:32768
    ds_read_b128 v[52:55], v5 offset:36864
    v_mfma_f32_32x32x16_bf16 v[32:47], v[120:123], v[60:63], v[32:47]
    ds_write_b128 v93, v[168:171] offset:16384
    buffer_load_dwordx4 v[116:119], v4, s[20:23], s33 offen offset:3072 sc1
    s_waitcnt vmcnt(12) lgkmcnt(4)
    v_mfma_f32_32x32x16_bf16 v[16:31], v[124:127], v[64:67], v[16:31]
    ds_read_b128 v[56:59], v6 offset:32768
    ds_read_b128 v[60:63], v6 offset:36864
    v_mfma_f32_32x32x16_bf16 v[32:47], v[124:127], v[68:71], v[32:47]
    ds_write_b128 v93, v[172:175] offset:17408
    s_add_u32 s33, s35, 49152
    buffer_load_dwordx4 v[120:123], v4, s[20:23], s33 offen offset:0 sc1
    s_waitcnt vmcnt(12) lgkmcnt(4)
    v_mfma_f32_32x32x16_bf16 v[16:31], v[128:131], v[48:51], v[16:31]
    ds_read_b128 v[64:67], v7 offset:32768
    ds_read_b128 v[68:71], v7 offset:36864
    v_mfma_f32_32x32x16_bf16 v[32:47], v[128:131], v[52:55], v[32:47]
    ds_write_b128 v93, v[176:179] offset:24576
    buffer_load_dwordx4 v[124:127], v4, s[20:23], s33 offen offset:1024 sc1
    s_waitcnt vmcnt(12) lgkmcnt(4)
    v_mfma_f32_32x32x16_bf16 v[16:31], v[132:135], v[56:59], v[16:31]
    ds_read_b128 v[48:51], v8 offset:32768
    ds_read_b128 v[52:55], v8 offset:36864
    v_mfma_f32_32x32x16_bf16 v[32:47], v[132:135], v[60:63], v[32:47]
    ds_write_b128 v93, v[180:183] offset:25600
    buffer_load_dwordx4 v[128:131], v4, s[20:23], s33 offen offset:2048 sc1
    s_waitcnt vmcnt(12) lgkmcnt(4)
    v_mfma_f32_32x32x16_bf16 v[16:31], v[136:139], v[64:67], v[16:31]
    ds_read_b128 v[56:59], v5 offset:40960
    ds_read_b128 v[60:63], v5 offset:45056
    v_mfma_f32_32x32x16_bf16 v[32:47], v[136:139], v[68:71], v[32:47]
    ds_write_b128 v93, v[184:187] offset:32768
    buffer_load_dwordx4 v[132:135], v4, s[20:23], s33 offen offset:3072 sc1
    s_waitcnt vmcnt(12) lgkmcnt(4)
    v_mfma_f32_32x32x16_bf16 v[16:31], v[140:143], v[48:51], v[16:31]
    ds_read_b128 v[64:67], v6 offset:40960
    ds_read_b128 v[68:71], v6 offset:45056
    v_mfma_f32_32x32x16_bf16 v[32:47], v[140:143], v[52:55], v[32:47]
    ds_write_b128 v93, v[188:191] offset:33792
    s_add_u32 s33, s35, 53248
    buffer_load_dwordx4 v[136:139], v4, s[20:23], s33 offen offset:0 sc1
    s_waitcnt vmcnt(12) lgkmcnt(4)
    v_mfma_f32_32x32x16_bf16 v[16:31], v[144:147], v[56:59], v[16:31]
    ds_read_b128 v[48:51], v7 offset:40960
    ds_read_b128 v[52:55], v7 offset:45056
    v_mfma_f32_32x32x16_bf16 v[32:47], v[144:147], v[60:63], v[32:47]
    buffer_load_dwordx4 v[140:143], v4, s[20:23], s33 offen offset:1024 sc1
    s_waitcnt vmcnt(12) lgkmcnt(3)
    v_mfma_f32_32x32x16_bf16 v[16:31], v[148:151], v[64:67], v[16:31]
    ds_read_b128 v[56:59], v8 offset:40960
    ds_read_b128 v[60:63], v8 offset:45056
    v_mfma_f32_32x32x16_bf16 v[32:47], v[148:151], v[68:71], v[32:47]
    buffer_load_dwordx4 v[144:147], v4, s[20:23], s33 offen offset:2048 sc1
    s_waitcnt vmcnt(12) lgkmcnt(2)
    v_mfma_f32_32x32x16_bf16 v[16:31], v[96:99], v[48:51], v[16:31]
    ds_read_b128 v[64:67], v12 offset:0
    ds_read_b128 v[68:71], v12 offset:4096
    v_mfma_f32_32x32x16_bf16 v[32:47], v[96:99], v[52:55], v[32:47]
    buffer_load_dwordx4 v[148:151], v4, s[20:23], s33 offen offset:3072 sc1
    s_waitcnt vmcnt(12) lgkmcnt(2)
    v_mfma_f32_32x32x16_bf16 v[16:31], v[100:103], v[56:59], v[16:31]
    ds_read_b128 v[48:51], v13 offset:0
    ds_read_b128 v[52:55], v13 offset:4096
    v_mfma_f32_32x32x16_bf16 v[32:47], v[100:103], v[60:63], v[32:47]
    s_add_u32 s33, s35, 57344
    buffer_load_dwordx4 v[96:99], v4, s[20:23], s33 offen offset:0 sc1
    s_waitcnt vmcnt(12) lgkmcnt(2)
    v_mfma_f32_32x32x16_bf16 v[16:31], v[104:107], v[64:67], v[16:31]
    ds_read_b128 v[56:59], v14 offset:0
    ds_read_b128 v[60:63], v14 offset:4096
    v_mfma_f32_32x32x16_bf16 v[32:47], v[104:107], v[68:71], v[32:47]
    buffer_load_dwordx4 v[100:103], v4, s[20:23], s33 offen offset:1024 sc1
    s_waitcnt vmcnt(12) lgkmcnt(2)
    v_mfma_f32_32x32x16_bf16 v[16:31], v[108:111], v[48:51], v[16:31]
    ds_read_b128 v[64:67], v15 offset:0
    ds_read_b128 v[68:71], v15 offset:4096
    v_mfma_f32_32x32x16_bf16 v[32:47], v[108:111], v[52:55], v[32:47]
    buffer_load_dwordx4 v[104:107], v4, s[20:23], s33 offen offset:2048 sc1
    s_waitcnt vmcnt(12) lgkmcnt(2)
    v_mfma_f32_32x32x16_bf16 v[16:31], v[112:115], v[56:59], v[16:31]
    s_waitcnt vmcnt(63) lgkmcnt(12)
    s_barrier
    ds_read_b128 v[48:51], v12 offset:8192
    ds_read_b128 v[52:55], v12 offset:12288
    v_mfma_f32_32x32x16_bf16 v[32:47], v[112:115], v[60:63], v[32:47]
    buffer_load_dwordx4 v[108:111], v4, s[20:23], s33 offen offset:3072 sc1
    s_waitcnt vmcnt(12) lgkmcnt(2)
    v_mfma_f32_32x32x16_bf16 v[16:31], v[116:119], v[64:67], v[16:31]
    ds_read_b128 v[56:59], v13 offset:8192
    ds_read_b128 v[60:63], v13 offset:12288
    v_mfma_f32_32x32x16_bf16 v[32:47], v[116:119], v[68:71], v[32:47]
    s_add_u32 s33, s35, 61440
    buffer_load_dwordx4 v[112:115], v4, s[20:23], s33 offen offset:0 sc1
    s_waitcnt vmcnt(12) lgkmcnt(2)
    v_mfma_f32_32x32x16_bf16 v[16:31], v[120:123], v[48:51], v[16:31]
    ds_read_b128 v[64:67], v14 offset:8192
    ds_read_b128 v[68:71], v14 offset:12288
    v_mfma_f32_32x32x16_bf16 v[32:47], v[120:123], v[52:55], v[32:47]
    ds_write_b128 v92, v[192:195] offset:0
    buffer_load_dwordx4 v[116:119], v4, s[20:23], s33 offen offset:1024 sc1
    s_waitcnt vmcnt(12) lgkmcnt(3)
    v_mfma_f32_32x32x16_bf16 v[16:31], v[124:127], v[56:59], v[16:31]
    ds_read_b128 v[48:51], v15 offset:8192
    ds_read_b128 v[52:55], v15 offset:12288
    v_mfma_f32_32x32x16_bf16 v[32:47], v[124:127], v[60:63], v[32:47]
    ds_write_b128 v92, v[196:199] offset:1024
    buffer_load_dwordx4 v[120:123], v4, s[20:23], s33 offen offset:2048 sc1
    s_waitcnt vmcnt(12) lgkmcnt(4)
    v_mfma_f32_32x32x16_bf16 v[16:31], v[128:131], v[64:67], v[16:31]
    ds_read_b128 v[56:59], v12 offset:16384
    ds_read_b128 v[60:63], v12 offset:20480
    v_mfma_f32_32x32x16_bf16 v[32:47], v[128:131], v[68:71], v[32:47]
    ds_write_b128 v92, v[200:203] offset:8192
    buffer_load_dwordx4 v[124:127], v4, s[20:23], s33 offen offset:3072 sc1
    s_waitcnt vmcnt(12) lgkmcnt(4)
    v_mfma_f32_32x32x16_bf16 v[16:31], v[132:135], v[48:51], v[16:31]
    ds_read_b128 v[64:67], v13 offset:16384
    ds_read_b128 v[68:71], v13 offset:20480
    v_mfma_f32_32x32x16_bf16 v[32:47], v[132:135], v[52:55], v[32:47]
    ds_write_b128 v92, v[204:207] offset:9216
    s_add_u32 s33, s35, 65536
    buffer_load_dwordx4 v[128:131], v4, s[20:23], s33 offen offset:0 sc1
    s_waitcnt vmcnt(12) lgkmcnt(4)
    v_mfma_f32_32x32x16_bf16 v[16:31], v[136:139], v[56:59], v[16:31]
    ds_read_b128 v[48:51], v14 offset:16384
    ds_read_b128 v[52:55], v14 offset:20480
    v_mfma_f32_32x32x16_bf16 v[32:47], v[136:139], v[60:63], v[32:47]
    ds_write_b128 v92, v[208:211] offset:16384
    buffer_load_dwordx4 v[132:135], v4, s[20:23], s33 offen offset:1024 sc1
    s_waitcnt vmcnt(12) lgkmcnt(4)
    v_mfma_f32_32x32x16_bf16 v[16:31], v[140:143], v[64:67], v[16:31]
    ds_read_b128 v[56:59], v15 offset:16384
    ds_read_b128 v[60:63], v15 offset:20480
    v_mfma_f32_32x32x16_bf16 v[32:47], v[140:143], v[68:71], v[32:47]
    ds_write_b128 v92, v[212:215] offset:17408
    buffer_load_dwordx4 v[136:139], v4, s[20:23], s33 offen offset:2048 sc1
    s_waitcnt vmcnt(12) lgkmcnt(4)
    v_mfma_f32_32x32x16_bf16 v[16:31], v[144:147], v[48:51], v[16:31]
    ds_read_b128 v[64:67], v12 offset:24576
    ds_read_b128 v[68:71], v12 offset:28672
    v_mfma_f32_32x32x16_bf16 v[32:47], v[144:147], v[52:55], v[32:47]
    ds_write_b128 v92, v[216:219] offset:24576
    buffer_load_dwordx4 v[140:143], v4, s[20:23], s33 offen offset:3072 sc1
    s_waitcnt vmcnt(12) lgkmcnt(4)
    v_mfma_f32_32x32x16_bf16 v[16:31], v[148:151], v[56:59], v[16:31]
    ds_read_b128 v[48:51], v13 offset:24576
    ds_read_b128 v[52:55], v13 offset:28672
    v_mfma_f32_32x32x16_bf16 v[32:47], v[148:151], v[60:63], v[32:47]
    ds_write_b128 v92, v[220:223] offset:25600
    s_add_u32 s33, s35, 69632
    buffer_load_dwordx4 v[144:147], v4, s[20:23], s33 offen offset:0 sc1
    s_waitcnt vmcnt(12) lgkmcnt(4)
    v_mfma_f32_32x32x16_bf16 v[16:31], v[96:99], v[64:67], v[16:31]
    ds_read_b128 v[56:59], v14 offset:24576
    ds_read_b128 v[60:63], v14 offset:28672
    v_mfma_f32_32x32x16_bf16 v[32:47], v[96:99], v[68:71], v[32:47]
    buffer_load_dwordx4 v[148:151], v4, s[20:23], s33 offen offset:1024 sc1
    s_waitcnt vmcnt(12) lgkmcnt(3)
    v_mfma_f32_32x32x16_bf16 v[16:31], v[100:103], v[48:51], v[16:31]
    ds_read_b128 v[64:67], v15 offset:24576
    ds_read_b128 v[68:71], v15 offset:28672
    v_mfma_f32_32x32x16_bf16 v[32:47], v[100:103], v[52:55], v[32:47]
    buffer_load_dwordx4 v[96:99], v4, s[20:23], s33 offen offset:2048 sc1
    s_waitcnt vmcnt(12) lgkmcnt(2)
    v_mfma_f32_32x32x16_bf16 v[16:31], v[104:107], v[56:59], v[16:31]
    ds_read_b128 v[48:51], v12 offset:32768
    ds_read_b128 v[52:55], v12 offset:36864
    v_mfma_f32_32x32x16_bf16 v[32:47], v[104:107], v[60:63], v[32:47]
    buffer_load_dwordx4 v[100:103], v4, s[20:23], s33 offen offset:3072 sc1
    s_waitcnt vmcnt(12) lgkmcnt(2)
    v_mfma_f32_32x32x16_bf16 v[16:31], v[108:111], v[64:67], v[16:31]
    ds_read_b128 v[56:59], v13 offset:32768
    ds_read_b128 v[60:63], v13 offset:36864
    v_mfma_f32_32x32x16_bf16 v[32:47], v[108:111], v[68:71], v[32:47]
    s_add_u32 s33, s35, 73728
    buffer_load_dwordx4 v[104:107], v4, s[20:23], s33 offen offset:0 sc1
    s_waitcnt vmcnt(12) lgkmcnt(2)
    v_mfma_f32_32x32x16_bf16 v[16:31], v[112:115], v[48:51], v[16:31]
    ds_read_b128 v[64:67], v14 offset:32768
    ds_read_b128 v[68:71], v14 offset:36864
    v_mfma_f32_32x32x16_bf16 v[32:47], v[112:115], v[52:55], v[32:47]
    buffer_load_dwordx4 v[108:111], v4, s[20:23], s33 offen offset:1024 sc1
    s_waitcnt vmcnt(12) lgkmcnt(2)
    v_mfma_f32_32x32x16_bf16 v[16:31], v[116:119], v[56:59], v[16:31]
    ds_read_b128 v[48:51], v15 offset:32768
    ds_read_b128 v[52:55], v15 offset:36864
    v_mfma_f32_32x32x16_bf16 v[32:47], v[116:119], v[60:63], v[32:47]
    buffer_load_dwordx4 v[112:115], v4, s[20:23], s33 offen offset:2048 sc1
    s_waitcnt vmcnt(12) lgkmcnt(2)
    v_mfma_f32_32x32x16_bf16 v[16:31], v[120:123], v[64:67], v[16:31]
    s_waitcnt vmcnt(63) lgkmcnt(12)
    s_barrier
    ds_read_b128 v[56:59], v5 offset:0
    ds_read_b128 v[60:63], v5 offset:4096
    v_mfma_f32_32x32x16_bf16 v[32:47], v[120:123], v[68:71], v[32:47]
    buffer_load_dwordx4 v[116:119], v4, s[20:23], s33 offen offset:3072 sc1
    s_waitcnt vmcnt(12) lgkmcnt(2)
    v_mfma_f32_32x32x16_bf16 v[16:31], v[124:127], v[48:51], v[16:31]
    ds_read_b128 v[64:67], v6 offset:0
    ds_read_b128 v[68:71], v6 offset:4096
    v_mfma_f32_32x32x16_bf16 v[32:47], v[124:127], v[52:55], v[32:47]
    s_add_u32 s33, s35, 77824
    buffer_load_dwordx4 v[120:123], v4, s[20:23], s33 offen offset:0 sc1
    s_waitcnt vmcnt(12) lgkmcnt(2)
    v_mfma_f32_32x32x16_bf16 v[16:31], v[128:131], v[56:59], v[16:31]
    ds_read_b128 v[48:51], v7 offset:0
    ds_read_b128 v[52:55], v7 offset:4096
    v_mfma_f32_32x32x16_bf16 v[32:47], v[128:131], v[60:63], v[32:47]
    ds_write_b128 v92, v[224:227] offset:32768
    buffer_load_dwordx4 v[124:127], v4, s[20:23], s33 offen offset:1024 sc1
    s_waitcnt vmcnt(12) lgkmcnt(3)
    v_mfma_f32_32x32x16_bf16 v[16:31], v[132:135], v[64:67], v[16:31]
    ds_read_b128 v[56:59], v8 offset:0
    ds_read_b128 v[60:63], v8 offset:4096
    v_mfma_f32_32x32x16_bf16 v[32:47], v[132:135], v[68:71], v[32:47]
    ds_write_b128 v92, v[228:231] offset:33792
    buffer_load_dwordx4 v[128:131], v4, s[20:23], s33 offen offset:2048 sc1
    s_waitcnt vmcnt(12) lgkmcnt(4)
    v_mfma_f32_32x32x16_bf16 v[16:31], v[136:139], v[48:51], v[16:31]
    ds_read_b128 v[64:67], v5 offset:8192
    ds_read_b128 v[68:71], v5 offset:12288
    v_mfma_f32_32x32x16_bf16 v[32:47], v[136:139], v[52:55], v[32:47]
    ds_write_b128 v92, v[232:235] offset:40960
    buffer_load_dwordx4 v[132:135], v4, s[20:23], s33 offen offset:3072 sc1
    s_waitcnt vmcnt(12) lgkmcnt(4)
    v_mfma_f32_32x32x16_bf16 v[16:31], v[140:143], v[56:59], v[16:31]
    ds_read_b128 v[48:51], v6 offset:8192
    ds_read_b128 v[52:55], v6 offset:12288
    v_mfma_f32_32x32x16_bf16 v[32:47], v[140:143], v[60:63], v[32:47]
    ds_write_b128 v92, v[236:239] offset:41984
    s_add_u32 s33, s35, 81920
    buffer_load_dwordx4 v[136:139], v4, s[20:23], s33 offen offset:0 sc1
    s_waitcnt vmcnt(12) lgkmcnt(4)
    v_mfma_f32_32x32x16_bf16 v[16:31], v[144:147], v[64:67], v[16:31]
    ds_read_b128 v[56:59], v7 offset:8192
    ds_read_b128 v[60:63], v7 offset:12288
    v_mfma_f32_32x32x16_bf16 v[32:47], v[144:147], v[68:71], v[32:47]
    ds_write_b128 v93, v[240:243] offset:0
    buffer_load_dwordx4 v[140:143], v4, s[20:23], s33 offen offset:1024 sc1
    s_waitcnt vmcnt(12) lgkmcnt(4)
    v_mfma_f32_32x32x16_bf16 v[16:31], v[148:151], v[48:51], v[16:31]
    ds_read_b128 v[64:67], v8 offset:8192
    ds_read_b128 v[68:71], v8 offset:12288
    v_mfma_f32_32x32x16_bf16 v[32:47], v[148:151], v[52:55], v[32:47]
    ds_write_b128 v93, v[244:247] offset:1024
    buffer_load_dwordx4 v[144:147], v4, s[20:23], s33 offen offset:2048 sc1
    s_waitcnt vmcnt(12) lgkmcnt(4)
    v_mfma_f32_32x32x16_bf16 v[16:31], v[96:99], v[56:59], v[16:31]
    ds_read_b128 v[48:51], v5 offset:16384
    ds_read_b128 v[52:55], v5 offset:20480
    v_mfma_f32_32x32x16_bf16 v[32:47], v[96:99], v[60:63], v[32:47]
    ds_write_b128 v93, v[248:251] offset:8192
    buffer_load_dwordx4 v[148:151], v4, s[20:23], s33 offen offset:3072 sc1
    s_waitcnt vmcnt(12) lgkmcnt(4)
    v_mfma_f32_32x32x16_bf16 v[16:31], v[100:103], v[64:67], v[16:31]
    ds_read_b128 v[56:59], v6 offset:16384
    ds_read_b128 v[60:63], v6 offset:20480
    v_mfma_f32_32x32x16_bf16 v[32:47], v[100:103], v[68:71], v[32:47]
    ds_write_b128 v93, v[252:255] offset:9216
    s_add_u32 s33, s35, 86016
    buffer_load_dwordx4 v[96:99], v4, s[20:23], s33 offen offset:0 sc1
    s_waitcnt vmcnt(12) lgkmcnt(4)
    v_mfma_f32_32x32x16_bf16 v[16:31], v[104:107], v[48:51], v[16:31]
    ds_read_b128 v[64:67], v7 offset:16384
    ds_read_b128 v[68:71], v7 offset:20480
    v_mfma_f32_32x32x16_bf16 v[32:47], v[104:107], v[52:55], v[32:47]
    buffer_load_dwordx4 v[100:103], v4, s[20:23], s33 offen offset:1024 sc1
    s_waitcnt vmcnt(12) lgkmcnt(3)
    v_mfma_f32_32x32x16_bf16 v[16:31], v[108:111], v[56:59], v[16:31]
    ds_read_b128 v[48:51], v8 offset:16384
    ds_read_b128 v[52:55], v8 offset:20480
    v_mfma_f32_32x32x16_bf16 v[32:47], v[108:111], v[60:63], v[32:47]
    buffer_load_dwordx4 v[104:107], v4, s[20:23], s33 offen offset:2048 sc1
    s_waitcnt vmcnt(12) lgkmcnt(2)
    v_mfma_f32_32x32x16_bf16 v[16:31], v[112:115], v[64:67], v[16:31]
    ds_read_b128 v[56:59], v5 offset:24576
    ds_read_b128 v[60:63], v5 offset:28672
    v_mfma_f32_32x32x16_bf16 v[32:47], v[112:115], v[68:71], v[32:47]
    buffer_load_dwordx4 v[108:111], v4, s[20:23], s33 offen offset:3072 sc1
    s_waitcnt vmcnt(12) lgkmcnt(2)
    v_mfma_f32_32x32x16_bf16 v[16:31], v[116:119], v[48:51], v[16:31]
    ds_read_b128 v[64:67], v6 offset:24576
    ds_read_b128 v[68:71], v6 offset:28672
    v_mfma_f32_32x32x16_bf16 v[32:47], v[116:119], v[52:55], v[32:47]
    s_add_u32 s33, s35, 90112
    buffer_load_dwordx4 v[112:115], v4, s[20:23], s33 offen offset:0 sc1
    s_waitcnt vmcnt(12) lgkmcnt(2)
    v_mfma_f32_32x32x16_bf16 v[16:31], v[120:123], v[56:59], v[16:31]
    ds_read_b128 v[48:51], v7 offset:24576
    ds_read_b128 v[52:55], v7 offset:28672
    v_mfma_f32_32x32x16_bf16 v[32:47], v[120:123], v[60:63], v[32:47]
    buffer_load_dwordx4 v[116:119], v4, s[20:23], s33 offen offset:1024 sc1
    s_waitcnt vmcnt(12) lgkmcnt(2)
    v_mfma_f32_32x32x16_bf16 v[16:31], v[124:127], v[64:67], v[16:31]
    ds_read_b128 v[56:59], v8 offset:24576
    ds_read_b128 v[60:63], v8 offset:28672
    v_mfma_f32_32x32x16_bf16 v[32:47], v[124:127], v[68:71], v[32:47]
    buffer_load_dwordx4 v[120:123], v4, s[20:23], s33 offen offset:2048 sc1
    s_waitcnt vmcnt(12) lgkmcnt(2)
    v_mfma_f32_32x32x16_bf16 v[16:31], v[128:131], v[48:51], v[16:31]
    s_waitcnt vmcnt(63) lgkmcnt(12)
    s_barrier
    ds_read_b128 v[64:67], v5 offset:32768
    ds_read_b128 v[68:71], v5 offset:36864
    v_mfma_f32_32x32x16_bf16 v[32:47], v[128:131], v[52:55], v[32:47]
    buffer_load_dwordx4 v[124:127], v4, s[20:23], s33 offen offset:3072 sc1
    s_waitcnt vmcnt(12) lgkmcnt(2)
    v_mfma_f32_32x32x16_bf16 v[16:31], v[132:135], v[56:59], v[16:31]
    ds_read_b128 v[48:51], v6 offset:32768
    ds_read_b128 v[52:55], v6 offset:36864
    v_mfma_f32_32x32x16_bf16 v[32:47], v[132:135], v[60:63], v[32:47]
    s_add_u32 s33, s35, 94208
    buffer_load_dwordx4 v[128:131], v4, s[20:23], s33 offen offset:0 sc1
    s_waitcnt vmcnt(12) lgkmcnt(2)
    v_mfma_f32_32x32x16_bf16 v[16:31], v[136:139], v[64:67], v[16:31]
    ds_read_b128 v[56:59], v7 offset:32768
    ds_read_b128 v[60:63], v7 offset:36864
    v_mfma_f32_32x32x16_bf16 v[32:47], v[136:139], v[68:71], v[32:47]
    buffer_load_dwordx4 v[132:135], v4, s[20:23], s33 offen offset:1024 sc1
    s_waitcnt vmcnt(12) lgkmcnt(2)
    v_mfma_f32_32x32x16_bf16 v[16:31], v[140:143], v[48:51], v[16:31]
    ds_read_b128 v[64:67], v8 offset:32768
    ds_read_b128 v[68:71], v8 offset:36864
    v_mfma_f32_32x32x16_bf16 v[32:47], v[140:143], v[52:55], v[32:47]
    buffer_load_dwordx4 v[136:139], v4, s[20:23], s33 offen offset:2048 sc1
    s_waitcnt vmcnt(12) lgkmcnt(2)
    v_mfma_f32_32x32x16_bf16 v[16:31], v[144:147], v[56:59], v[16:31]
    ds_read_b128 v[48:51], v5 offset:40960
    ds_read_b128 v[52:55], v5 offset:45056
    v_mfma_f32_32x32x16_bf16 v[32:47], v[144:147], v[60:63], v[32:47]
    buffer_load_dwordx4 v[140:143], v4, s[20:23], s33 offen offset:3072 sc1
    s_waitcnt vmcnt(12) lgkmcnt(2)
    v_mfma_f32_32x32x16_bf16 v[16:31], v[148:151], v[64:67], v[16:31]
    ds_read_b128 v[56:59], v6 offset:40960
    ds_read_b128 v[60:63], v6 offset:45056
    v_mfma_f32_32x32x16_bf16 v[32:47], v[148:151], v[68:71], v[32:47]
    s_add_u32 s33, s35, 98304
    buffer_load_dwordx4 v[144:147], v4, s[20:23], s33 offen offset:0 sc1
    s_waitcnt vmcnt(12) lgkmcnt(2)
    v_mfma_f32_32x32x16_bf16 v[16:31], v[96:99], v[48:51], v[16:31]
    ds_read_b128 v[64:67], v7 offset:40960
    ds_read_b128 v[68:71], v7 offset:45056
    v_mfma_f32_32x32x16_bf16 v[32:47], v[96:99], v[52:55], v[32:47]
    buffer_load_dwordx4 v[148:151], v4, s[20:23], s33 offen offset:1024 sc1
    buffer_load_dwordx4 v[72:75], v4, s[20:23], s40 offen offset:0 sc1
    s_waitcnt vmcnt(13) lgkmcnt(2)
    v_mfma_f32_32x32x16_bf16 v[16:31], v[100:103], v[56:59], v[16:31]
    ds_read_b128 v[48:51], v8 offset:40960
    ds_read_b128 v[52:55], v8 offset:45056
    v_mfma_f32_32x32x16_bf16 v[32:47], v[100:103], v[60:63], v[32:47]
    buffer_load_dwordx4 v[96:99], v4, s[20:23], s33 offen offset:2048 sc1
    buffer_load_dwordx4 v[76:79], v4, s[20:23], s40 offen offset:1024 sc1
    s_waitcnt vmcnt(14) lgkmcnt(2)
    v_mfma_f32_32x32x16_bf16 v[16:31], v[104:107], v[64:67], v[16:31]
    ds_read_b128 v[56:59], v12 offset:0
    ds_read_b128 v[60:63], v12 offset:4096
    v_mfma_f32_32x32x16_bf16 v[32:47], v[104:107], v[68:71], v[32:47]
    buffer_load_dwordx4 v[100:103], v4, s[20:23], s33 offen offset:3072 sc1
    buffer_load_dwordx4 v[80:83], v4, s[20:23], s40 offen offset:2048 sc1
    s_waitcnt vmcnt(15) lgkmcnt(2)
    v_mfma_f32_32x32x16_bf16 v[16:31], v[108:111], v[48:51], v[16:31]
    ds_read_b128 v[64:67], v13 offset:0
    ds_read_b128 v[68:71], v13 offset:4096
    v_mfma_f32_32x32x16_bf16 v[32:47], v[108:111], v[52:55], v[32:47]
    s_add_u32 s33, s35, 102400
    buffer_load_dwordx4 v[104:107], v4, s[20:23], s33 offen offset:0 sc1
    buffer_load_dwordx4 v[84:87], v4, s[20:23], s40 offen offset:3072 sc1
    s_waitcnt vmcnt(16) lgkmcnt(2)
    v_mfma_f32_32x32x16_bf16 v[16:31], v[112:115], v[56:59], v[16:31]
    ds_read_b128 v[48:51], v14 offset:0
    ds_read_b128 v[52:55], v14 offset:4096
    v_mfma_f32_32x32x16_bf16 v[32:47], v[112:115], v[60:63], v[32:47]
    buffer_load_dwordx4 v[108:111], v4, s[20:23], s33 offen offset:1024 sc1
    buffer_load_ushort v88, v11, s[16:19], s41 offen offset:0
    s_waitcnt vmcnt(17) lgkmcnt(2)
    v_mfma_f32_32x32x16_bf16 v[16:31], v[116:119], v[64:67], v[16:31]
    ds_read_b128 v[56:59], v15 offset:0
    ds_read_b128 v[60:63], v15 offset:4096
    v_mfma_f32_32x32x16_bf16 v[32:47], v[116:119], v[68:71], v[32:47]
    buffer_load_dwordx4 v[112:115], v4, s[20:23], s33 offen offset:2048 sc1
    buffer_load_ushort v90, v11, s[16:19], s41 offen offset:64
    s_waitcnt vmcnt(18) lgkmcnt(2)
    v_mfma_f32_32x32x16_bf16 v[16:31], v[120:123], v[48:51], v[16:31]
    ds_read_b128 v[64:67], v12 offset:8192
    ds_read_b128 v[68:71], v12 offset:12288
    v_mfma_f32_32x32x16_bf16 v[32:47], v[120:123], v[52:55], v[32:47]
    buffer_load_dwordx4 v[116:119], v4, s[20:23], s33 offen offset:3072 sc1
    s_waitcnt vmcnt(18) lgkmcnt(2)
    v_mfma_f32_32x32x16_bf16 v[16:31], v[124:127], v[56:59], v[16:31]
    ds_read_b128 v[48:51], v13 offset:8192
    ds_read_b128 v[52:55], v13 offset:12288
    v_mfma_f32_32x32x16_bf16 v[32:47], v[124:127], v[60:63], v[32:47]
    s_add_u32 s33, s35, 106496
    buffer_load_dwordx4 v[120:123], v4, s[20:23], s33 offen offset:0 sc1
    s_waitcnt vmcnt(18) lgkmcnt(2)
    v_mfma_f32_32x32x16_bf16 v[16:31], v[128:131], v[64:67], v[16:31]
    ds_read_b128 v[56:59], v14 offset:8192
    ds_read_b128 v[60:63], v14 offset:12288
    v_mfma_f32_32x32x16_bf16 v[32:47], v[128:131], v[68:71], v[32:47]
    buffer_load_dwordx4 v[124:127], v4, s[20:23], s33 offen offset:1024 sc1
    s_waitcnt vmcnt(18) lgkmcnt(2)
    v_mfma_f32_32x32x16_bf16 v[16:31], v[132:135], v[48:51], v[16:31]
    ds_read_b128 v[64:67], v15 offset:8192
    ds_read_b128 v[68:71], v15 offset:12288
    v_mfma_f32_32x32x16_bf16 v[32:47], v[132:135], v[52:55], v[32:47]
    buffer_load_dwordx4 v[128:131], v4, s[20:23], s33 offen offset:2048 sc1
    s_waitcnt vmcnt(18) lgkmcnt(2)
    v_mfma_f32_32x32x16_bf16 v[16:31], v[136:139], v[56:59], v[16:31]
    s_waitcnt vmcnt(63) lgkmcnt(15)
    s_barrier
    ds_read_b128 v[48:51], v12 offset:16384
    ds_read_b128 v[52:55], v12 offset:20480
    v_mfma_f32_32x32x16_bf16 v[32:47], v[136:139], v[60:63], v[32:47]
    buffer_load_dwordx4 v[132:135], v4, s[20:23], s33 offen offset:3072 sc1
    s_waitcnt vmcnt(18) lgkmcnt(2)
    v_mfma_f32_32x32x16_bf16 v[16:31], v[140:143], v[64:67], v[16:31]
    ds_read_b128 v[56:59], v13 offset:16384
    ds_read_b128 v[60:63], v13 offset:20480
    v_mfma_f32_32x32x16_bf16 v[32:47], v[140:143], v[68:71], v[32:47]
    s_add_u32 s33, s35, 110592
    buffer_load_dwordx4 v[136:139], v4, s[20:23], s33 offen offset:0 sc1
    s_waitcnt vmcnt(18) lgkmcnt(2)
    v_mfma_f32_32x32x16_bf16 v[16:31], v[144:147], v[48:51], v[16:31]
    ds_read_b128 v[64:67], v14 offset:16384
    ds_read_b128 v[68:71], v14 offset:20480
    v_mfma_f32_32x32x16_bf16 v[32:47], v[144:147], v[52:55], v[32:47]
    buffer_load_dwordx4 v[140:143], v4, s[20:23], s33 offen offset:1024 sc1
    s_waitcnt vmcnt(18) lgkmcnt(2)
    v_mfma_f32_32x32x16_bf16 v[16:31], v[148:151], v[56:59], v[16:31]
    ds_read_b128 v[48:51], v15 offset:16384
    ds_read_b128 v[52:55], v15 offset:20480
    v_mfma_f32_32x32x16_bf16 v[32:47], v[148:151], v[60:63], v[32:47]
    buffer_load_dwordx4 v[144:147], v4, s[20:23], s33 offen offset:2048 sc1
    s_waitcnt vmcnt(17) lgkmcnt(2)
    v_mfma_f32_32x32x16_bf16 v[16:31], v[96:99], v[64:67], v[16:31]
    ds_read_b128 v[56:59], v12 offset:24576
    ds_read_b128 v[60:63], v12 offset:28672
    v_mfma_f32_32x32x16_bf16 v[32:47], v[96:99], v[68:71], v[32:47]
    buffer_load_dwordx4 v[148:151], v4, s[20:23], s33 offen offset:3072 sc1
    s_waitcnt vmcnt(16) lgkmcnt(2)
    v_mfma_f32_32x32x16_bf16 v[16:31], v[100:103], v[48:51], v[16:31]
    ds_read_b128 v[64:67], v13 offset:24576
    ds_read_b128 v[68:71], v13 offset:28672
    v_mfma_f32_32x32x16_bf16 v[32:47], v[100:103], v[52:55], v[32:47]
    s_add_u32 s33, s35, 114688
    buffer_load_dwordx4 v[96:99], v4, s[20:23], s33 offen offset:0 sc1
    s_waitcnt vmcnt(15) lgkmcnt(2)
    v_mfma_f32_32x32x16_bf16 v[16:31], v[104:107], v[56:59], v[16:31]
    ds_read_b128 v[48:51], v14 offset:24576
    ds_read_b128 v[52:55], v14 offset:28672
    v_mfma_f32_32x32x16_bf16 v[32:47], v[104:107], v[60:63], v[32:47]
    buffer_load_dwordx4 v[100:103], v4, s[20:23], s33 offen offset:1024 sc1
    s_waitcnt vmcnt(14) lgkmcnt(2)
    v_mfma_f32_32x32x16_bf16 v[16:31], v[108:111], v[64:67], v[16:31]
    ds_read_b128 v[56:59], v15 offset:24576
    ds_read_b128 v[60:63], v15 offset:28672
    v_mfma_f32_32x32x16_bf16 v[32:47], v[108:111], v[68:71], v[32:47]
    buffer_load_dwordx4 v[104:107], v4, s[20:23], s33 offen offset:2048 sc1
    s_waitcnt vmcnt(13) lgkmcnt(2)
    v_mfma_f32_32x32x16_bf16 v[16:31], v[112:115], v[48:51], v[16:31]
    ds_read_b128 v[64:67], v12 offset:32768
    ds_read_b128 v[68:71], v12 offset:36864
    v_mfma_f32_32x32x16_bf16 v[32:47], v[112:115], v[52:55], v[32:47]
    buffer_load_dwordx4 v[108:111], v4, s[20:23], s33 offen offset:3072 sc1
    s_waitcnt vmcnt(12) lgkmcnt(2)
    v_mfma_f32_32x32x16_bf16 v[16:31], v[116:119], v[56:59], v[16:31]
    ds_read_b128 v[48:51], v13 offset:32768
    ds_read_b128 v[52:55], v13 offset:36864
    v_mfma_f32_32x32x16_bf16 v[32:47], v[116:119], v[60:63], v[32:47]
    s_add_u32 s33, s35, 118784
    buffer_load_dwordx4 v[112:115], v4, s[20:23], s33 offen offset:0 sc1
    s_waitcnt vmcnt(12) lgkmcnt(2)
    v_mfma_f32_32x32x16_bf16 v[16:31], v[120:123], v[64:67], v[16:31]
    ds_read_b128 v[56:59], v14 offset:32768
    ds_read_b128 v[60:63], v14 offset:36864
    v_mfma_f32_32x32x16_bf16 v[32:47], v[120:123], v[68:71], v[32:47]
    buffer_load_dwordx4 v[116:119], v4, s[20:23], s33 offen offset:1024 sc1
    s_waitcnt vmcnt(15)
    v_lshlrev_b32 v88, 16, v88
    v_lshlrev_b32 v90, 16, v90
    s_waitcnt vmcnt(12) lgkmcnt(2)
    v_mfma_f32_32x32x16_bf16 v[16:31], v[124:127], v[48:51], v[16:31]
    ds_read_b128 v[64:67], v15 offset:32768
    ds_read_b128 v[68:71], v15 offset:36864
    v_mfma_f32_32x32x16_bf16 v[32:47], v[124:127], v[52:55], v[32:47]
    buffer_load_dwordx4 v[120:123], v4, s[20:23], s33 offen offset:2048 sc1
    v_lshlrev_b32 v208, 16, v72
    v_and_b32 v209, 0xffff0000, v72
    s_waitcnt vmcnt(12) lgkmcnt(2)
    v_mfma_f32_32x32x16_bf16 v[16:31], v[128:131], v[56:59], v[16:31]
    ds_read_b128 v[48:51], v5 offset:0
    ds_read_b128 v[52:55], v5 offset:4096
    v_mfma_f32_32x32x16_bf16 v[32:47], v[128:131], v[60:63], v[32:47]
    buffer_load_dwordx4 v[124:127], v4, s[20:23], s33 offen offset:3072 sc1
    v_lshlrev_b32 v210, 16, v73
    v_and_b32 v211, 0xffff0000, v73
    s_waitcnt vmcnt(12) lgkmcnt(2)
    v_mfma_f32_32x32x16_bf16 v[16:31], v[132:135], v[64:67], v[16:31]
    ds_read_b128 v[56:59], v6 offset:0
    ds_read_b128 v[60:63], v6 offset:4096
    v_mfma_f32_32x32x16_bf16 v[32:47], v[132:135], v[68:71], v[32:47]
    s_add_u32 s33, s35, 122880
    buffer_load_dwordx4 v[128:131], v4, s[20:23], s33 offen offset:0 sc1
    v_lshlrev_b32 v212, 16, v74
    v_and_b32 v213, 0xffff0000, v74
    s_waitcnt vmcnt(12) lgkmcnt(2)
    v_mfma_f32_32x32x16_bf16 v[16:31], v[136:139], v[48:51], v[16:31]
    ds_read_b128 v[64:67], v7 offset:0
    ds_read_b128 v[68:71], v7 offset:4096
    v_mfma_f32_32x32x16_bf16 v[32:47], v[136:139], v[52:55], v[32:47]
    buffer_load_dwordx4 v[132:135], v4, s[20:23], s33 offen offset:1024 sc1
    v_lshlrev_b32 v214, 16, v75
    v_and_b32 v215, 0xffff0000, v75
    s_waitcnt vmcnt(12) lgkmcnt(2)
    v_mfma_f32_32x32x16_bf16 v[16:31], v[140:143], v[56:59], v[16:31]
    ds_read_b128 v[48:51], v8 offset:0
    ds_read_b128 v[52:55], v8 offset:4096
    v_mfma_f32_32x32x16_bf16 v[32:47], v[140:143], v[60:63], v[32:47]
    buffer_load_dwordx4 v[136:139], v4, s[20:23], s33 offen offset:2048 sc1
    v_lshlrev_b32 v216, 16, v76
    v_and_b32 v217, 0xffff0000, v76
    s_waitcnt vmcnt(12) lgkmcnt(2)
    v_mfma_f32_32x32x16_bf16 v[16:31], v[144:147], v[64:67], v[16:31]
    s_waitcnt vmcnt(63) lgkmcnt(15)
    s_barrier
    ds_read_b128 v[56:59], v5 offset:8192
    ds_read_b128 v[60:63], v5 offset:12288
    v_mfma_f32_32x32x16_bf16 v[32:47], v[144:147], v[68:71], v[32:47]
    buffer_load_dwordx4 v[140:143], v4, s[20:23], s33 offen offset:3072 sc1
    v_lshlrev_b32 v218, 16, v77
    v_and_b32 v219, 0xffff0000, v77
    s_waitcnt vmcnt(12) lgkmcnt(2)
    v_mfma_f32_32x32x16_bf16 v[16:31], v[148:151], v[48:51], v[16:31]
    ds_read_b128 v[64:67], v6 offset:8192
    ds_read_b128 v[68:71], v6 offset:12288
    v_mfma_f32_32x32x16_bf16 v[32:47], v[148:151], v[52:55], v[32:47]
    s_add_u32 s33, s35, 126976
    buffer_load_dwordx4 v[144:147], v4, s[20:23], s33 offen offset:0 sc1
    v_lshlrev_b32 v220, 16, v78
    v_and_b32 v221, 0xffff0000, v78
    s_waitcnt vmcnt(12) lgkmcnt(2)
    v_mfma_f32_32x32x16_bf16 v[16:31], v[96:99], v[56:59], v[16:31]
    ds_read_b128 v[48:51], v7 offset:8192
    ds_read_b128 v[52:55], v7 offset:12288
    v_mfma_f32_32x32x16_bf16 v[32:47], v[96:99], v[60:63], v[32:47]
    buffer_load_dwordx4 v[148:151], v4, s[20:23], s33 offen offset:1024 sc1
    v_lshlrev_b32 v222, 16, v79
    v_and_b32 v223, 0xffff0000, v79
    s_waitcnt vmcnt(12) lgkmcnt(2)
    v_mfma_f32_32x32x16_bf16 v[16:31], v[100:103], v[64:67], v[16:31]
    ds_read_b128 v[56:59], v8 offset:8192
    ds_read_b128 v[60:63], v8 offset:12288
    v_mfma_f32_32x32x16_bf16 v[32:47], v[100:103], v[68:71], v[32:47]
    buffer_load_dwordx4 v[96:99], v4, s[20:23], s33 offen offset:2048 sc1
    v_lshlrev_b32 v224, 16, v80
    v_and_b32 v225, 0xffff0000, v80
    s_waitcnt vmcnt(12) lgkmcnt(2)
    v_mfma_f32_32x32x16_bf16 v[16:31], v[104:107], v[48:51], v[16:31]
    ds_read_b128 v[64:67], v5 offset:16384
    ds_read_b128 v[68:71], v5 offset:20480
    v_mfma_f32_32x32x16_bf16 v[32:47], v[104:107], v[52:55], v[32:47]
    buffer_load_dwordx4 v[100:103], v4, s[20:23], s33 offen offset:3072 sc1
    v_lshlrev_b32 v226, 16, v81
    v_and_b32 v227, 0xffff0000, v81
    s_waitcnt vmcnt(12) lgkmcnt(2)
    v_mfma_f32_32x32x16_bf16 v[16:31], v[108:111], v[56:59], v[16:31]
    ds_read_b128 v[48:51], v6 offset:16384
    ds_read_b128 v[52:55], v6 offset:20480
    v_mfma_f32_32x32x16_bf16 v[32:47], v[108:111], v[60:63], v[32:47]
    v_lshlrev_b32 v228, 16, v82
    v_and_b32 v229, 0xffff0000, v82
    s_waitcnt vmcnt(11) lgkmcnt(2)
    v_mfma_f32_32x32x16_bf16 v[16:31], v[112:115], v[64:67], v[16:31]
    ds_read_b128 v[56:59], v7 offset:16384
    ds_read_b128 v[60:63], v7 offset:20480
    v_mfma_f32_32x32x16_bf16 v[32:47], v[112:115], v[68:71], v[32:47]
    v_lshlrev_b32 v230, 16, v83
    v_and_b32 v231, 0xffff0000, v83
    s_waitcnt vmcnt(10) lgkmcnt(2)
    v_mfma_f32_32x32x16_bf16 v[16:31], v[116:119], v[48:51], v[16:31]
    ds_read_b128 v[64:67], v8 offset:16384
    ds_read_b128 v[68:71], v8 offset:20480
    v_mfma_f32_32x32x16_bf16 v[32:47], v[116:119], v[52:55], v[32:47]
    v_lshlrev_b32 v232, 16, v84
    v_and_b32 v233, 0xffff0000, v84
    s_waitcnt vmcnt(9) lgkmcnt(2)
    v_mfma_f32_32x32x16_bf16 v[16:31], v[120:123], v[56:59], v[16:31]
    ds_read_b128 v[48:51], v5 offset:24576
    ds_read_b128 v[52:55], v5 offset:28672
    v_mfma_f32_32x32x16_bf16 v[32:47], v[120:123], v[60:63], v[32:47]
    v_lshlrev_b32 v234, 16, v85
    v_and_b32 v235, 0xffff0000, v85
    s_waitcnt vmcnt(8) lgkmcnt(2)
    v_mfma_f32_32x32x16_bf16 v[16:31], v[124:127], v[64:67], v[16:31]
    ds_read_b128 v[56:59], v6 offset:24576
    ds_read_b128 v[60:63], v6 offset:28672
    v_mfma_f32_32x32x16_bf16 v[32:47], v[124:127], v[68:71], v[32:47]
    v_lshlrev_b32 v236, 16, v86
    v_and_b32 v237, 0xffff0000, v86
    s_waitcnt vmcnt(7) lgkmcnt(2)
    v_mfma_f32_32x32x16_bf16 v[16:31], v[128:131], v[48:51], v[16:31]
    ds_read_b128 v[64:67], v7 offset:24576
    ds_read_b128 v[68:71], v7 offset:28672
    v_mfma_f32_32x32x16_bf16 v[32:47], v[128:131], v[52:55], v[32:47]
    v_lshlrev_b32 v238, 16, v87
    v_and_b32 v239, 0xffff0000, v87
    s_waitcnt vmcnt(6) lgkmcnt(2)
    v_mfma_f32_32x32x16_bf16 v[16:31], v[132:135], v[56:59], v[16:31]
    ds_read_b128 v[48:51], v8 offset:24576
    ds_read_b128 v[52:55], v8 offset:28672
    v_mfma_f32_32x32x16_bf16 v[32:47], v[132:135], v[60:63], v[32:47]
    s_waitcnt vmcnt(5) lgkmcnt(2)
    v_mfma_f32_32x32x16_bf16 v[16:31], v[136:139], v[64:67], v[16:31]
    ds_read_b128 v[56:59], v5 offset:32768
    ds_read_b128 v[60:63], v5 offset:36864
    v_mfma_f32_32x32x16_bf16 v[32:47], v[136:139], v[68:71], v[32:47]
    s_waitcnt vmcnt(4) lgkmcnt(2)
    v_mfma_f32_32x32x16_bf16 v[16:31], v[140:143], v[48:51], v[16:31]
    ds_read_b128 v[64:67], v6 offset:32768
    ds_read_b128 v[68:71], v6 offset:36864
    v_mfma_f32_32x32x16_bf16 v[32:47], v[140:143], v[52:55], v[32:47]
    s_waitcnt vmcnt(3) lgkmcnt(2)
    v_mfma_f32_32x32x16_bf16 v[16:31], v[144:147], v[56:59], v[16:31]
    ds_read_b128 v[48:51], v7 offset:32768
    ds_read_b128 v[52:55], v7 offset:36864
    v_mfma_f32_32x32x16_bf16 v[32:47], v[144:147], v[60:63], v[32:47]
    s_waitcnt vmcnt(2) lgkmcnt(2)
    v_mfma_f32_32x32x16_bf16 v[16:31], v[148:151], v[64:67], v[16:31]
    ds_read_b128 v[56:59], v8 offset:32768
    ds_read_b128 v[60:63], v8 offset:36864
    v_mfma_f32_32x32x16_bf16 v[32:47], v[148:151], v[68:71], v[32:47]
    s_waitcnt vmcnt(1) lgkmcnt(2)
    v_mfma_f32_32x32x16_bf16 v[16:31], v[96:99], v[48:51], v[16:31]
    v_mfma_f32_32x32x16_bf16 v[32:47], v[96:99], v[52:55], v[32:47]
    s_waitcnt vmcnt(0) lgkmcnt(0)
    v_mfma_f32_32x32x16_bf16 v[16:31], v[100:103], v[56:59], v[16:31]
    v_mfma_f32_32x32x16_bf16 v[32:47], v[100:103], v[60:63], v[32:47]
    s_nop 10
    v_pk_add_f32 v[16:17], v[16:17], v[88:89] op_sel_hi:[1,0]
    v_pk_add_f32 v[18:19], v[18:19], v[88:89] op_sel_hi:[1,0]
    v_pk_add_f32 v[20:21], v[20:21], v[88:89] op_sel_hi:[1,0]
    v_pk_add_f32 v[22:23], v[22:23], v[88:89] op_sel_hi:[1,0]
    v_pk_add_f32 v[24:25], v[24:25], v[88:89] op_sel_hi:[1,0]
    v_pk_add_f32 v[26:27], v[26:27], v[88:89] op_sel_hi:[1,0]
    v_pk_add_f32 v[28:29], v[28:29], v[88:89] op_sel_hi:[1,0]
    v_pk_add_f32 v[30:31], v[30:31], v[88:89] op_sel_hi:[1,0]
    v_pk_mul_f32 v[208:209], v[208:209], v[16:17]
    v_pk_mul_f32 v[210:211], v[210:211], v[18:19]
    v_pk_mul_f32 v[212:213], v[212:213], v[20:21]
    v_pk_mul_f32 v[214:215], v[214:215], v[22:23]
    v_pk_mul_f32 v[216:217], v[216:217], v[24:25]
    v_pk_mul_f32 v[218:219], v[218:219], v[26:27]
    v_pk_mul_f32 v[220:221], v[220:221], v[28:29]
    v_pk_mul_f32 v[222:223], v[222:223], v[30:31]
    v_cvt_pk_bf16_f32 v48, v208, v209
    v_cvt_pk_bf16_f32 v49, v210, v211
    v_cvt_pk_bf16_f32 v50, v212, v213
    v_cvt_pk_bf16_f32 v51, v214, v215
    v_cvt_pk_bf16_f32 v52, v216, v217
    v_cvt_pk_bf16_f32 v53, v218, v219
    v_cvt_pk_bf16_f32 v54, v220, v221
    v_cvt_pk_bf16_f32 v55, v222, v223
    v_permlane32_swap_b32 v48, v50
    v_permlane32_swap_b32 v49, v51
    v_permlane32_swap_b32 v52, v54
    v_permlane32_swap_b32 v53, v55
    buffer_store_dwordx4 v[48:51], v4, s[20:23], s40 offen offset:0 sc1
    buffer_store_dwordx4 v[52:55], v4, s[20:23], s40 offen offset:1024 sc1
    v_pk_add_f32 v[32:33], v[32:33], v[90:91] op_sel_hi:[1,0]
    v_pk_add_f32 v[34:35], v[34:35], v[90:91] op_sel_hi:[1,0]
    v_pk_add_f32 v[36:37], v[36:37], v[90:91] op_sel_hi:[1,0]
    v_pk_add_f32 v[38:39], v[38:39], v[90:91] op_sel_hi:[1,0]
    v_pk_add_f32 v[40:41], v[40:41], v[90:91] op_sel_hi:[1,0]
    v_pk_add_f32 v[42:43], v[42:43], v[90:91] op_sel_hi:[1,0]
    v_pk_add_f32 v[44:45], v[44:45], v[90:91] op_sel_hi:[1,0]
    v_pk_add_f32 v[46:47], v[46:47], v[90:91] op_sel_hi:[1,0]
    v_pk_mul_f32 v[224:225], v[224:225], v[32:33]
    v_pk_mul_f32 v[226:227], v[226:227], v[34:35]
    v_pk_mul_f32 v[228:229], v[228:229], v[36:37]
    v_pk_mul_f32 v[230:231], v[230:231], v[38:39]
    v_pk_mul_f32 v[232:233], v[232:233], v[40:41]
    v_pk_mul_f32 v[234:235], v[234:235], v[42:43]
    v_pk_mul_f32 v[236:237], v[236:237], v[44:45]
    v_pk_mul_f32 v[238:239], v[238:239], v[46:47]
    v_cvt_pk_bf16_f32 v56, v224, v225
    v_cvt_pk_bf16_f32 v57, v226, v227
    v_cvt_pk_bf16_f32 v58, v228, v229
    v_cvt_pk_bf16_f32 v59, v230, v231
    v_cvt_pk_bf16_f32 v60, v232, v233
    v_cvt_pk_bf16_f32 v61, v234, v235
    v_cvt_pk_bf16_f32 v62, v236, v237
    v_cvt_pk_bf16_f32 v63, v238, v239
    v_permlane32_swap_b32 v56, v58
    v_permlane32_swap_b32 v57, v59
    v_permlane32_swap_b32 v60, v62
    v_permlane32_swap_b32 v61, v63
    buffer_store_dwordx4 v[56:59], v4, s[20:23], s40 offen offset:2048 sc1
    buffer_store_dwordx4 v[60:63], v4, s[20:23], s40 offen offset:3072 sc1
    v_lshrrev_b32 v12, 5, v1
    v_bfe_u32 v13, v1, 2, 2
    v_lshl_add_u32 v14, v12, 3, v13
    v_lshlrev_b32 v14, 7, v14
    v_bfe_u32 v15, v1, 4, 1
    v_lshl_add_u32 v14, v15, 5, v14
    v_and_b32 v15, 3, v1
    v_lshl_add_u32 v14, v15, 3, v14
    v_bfe_u32 v15, v1, 3, 1
    v_lshl_add_u32 v14, v15, 6, v14
    s_mul_i32 s37, s24, 28672
    s_add_u32 s37, s37, 49152
    v_add_u32 v9, s37, v14
    v_xor_b32 v10, 64, v9
    v_add_u32 v5, s37, v4
    s_mul_i32 s35, s24, 917504
    s_lshl_b32 s36, s26, 12
    s_add_u32 s35, s35, s36
    s_mul_i32 s44, s26, 28
    s_add_u32 s45, s44, s27
    s_lshl_b32 s45, s45, 6
    s_add_u32 s45, s45, 21626880
    s_mul_i32 s46, s24, 7
    s_add_u32 s44, s44, s46
    s_lshl_b32 s44, s44, 6
    s_add_u32 s44, s44, 21626880
    v_min_u32 v6, 6, v1
    v_lshlrev_b32 v6, 6, v6
    v_mov_b32 v8, 0
    v_mov_b32 v2, v94
    v_mov_b32 v3, v95
    s_waitcnt vmcnt(0)
    s_mov_b64 exec, 1
    buffer_store_dwordx2 v[2:3], v8, s[20:23], s45 offen sc1
    s_mov_b64 exec, -1
    s_barrier
    s_mov_b32 s47, 0
F_pp_p:
    buffer_load_dwordx2 v[12:13], v6, s[20:23], s44 offen sc1
    s_waitcnt vmcnt(0)
    v_xor_b32 v12, v12, v2
    v_xor_b32 v13, v13, v3
    v_or_b32 v12, v12, v13
    v_cmp_ne_u32 vcc, 0, v12
    s_nop 1
    s_cbranch_vccz F_pp_ok
    s_add_u32 s47, s47, 1
    s_sleep 4
    s_cmp_gt_u32 s47, 0x100000
    s_cbranch_scc0 F_pp_p
F_pp_ok:
    buffer_load_dwordx4 v[96:99], v4, s[20:23], s35 offen offset:0 sc1
    buffer_load_dwordx4 v[100:103], v4, s[20:23], s35 offen offset:2048 sc1
    buffer_load_dwordx4 v[104:107], v4, s[20:23], s35 offen offset:1024 sc1
    buffer_load_dwordx4 v[108:111], v4, s[20:23], s35 offen offset:3072 sc1
    s_add_u32 s35, s35, 131072
    buffer_load_dwordx4 v[112:115], v4, s[20:23], s35 offen offset:0 sc1
    buffer_load_dwordx4 v[116:119], v4, s[20:23], s35 offen offset:2048 sc1
    buffer_load_dwordx4 v[120:123], v4, s[20:23], s35 offen offset:1024 sc1
    buffer_load_dwordx4 v[124:127], v4, s[20:23], s35 offen offset:3072 sc1
    s_add_u32 s35, s35, 131072
    buffer_load_dwordx4 v[128:131], v4, s[20:23], s35 offen offset:0 sc1
    buffer_load_dwordx4 v[132:135], v4, s[20:23], s35 offen offset:2048 sc1
    buffer_load_dwordx4 v[136:139], v4, s[20:23], s35 offen offset:1024 sc1
    buffer_load_dwordx4 v[140:143], v4, s[20:23], s35 offen offset:3072 sc1
    s_add_u32 s35, s35, 131072
    buffer_load_dwordx4 v[144:147], v4, s[20:23], s35 offen offset:0 sc1
    buffer_load_dwordx4 v[148:151], v4, s[20:23], s35 offen offset:2048 sc1
    buffer_load_dwordx4 v[152:155], v4, s[20:23], s35 offen offset:1024 sc1
    buffer_load_dwordx4 v[156:159], v4, s[20:23], s35 offen offset:3072 sc1
    ds_read_b64_tr_b16 v[80:81], v9 offset:0
    ds_read_b64_tr_b16 v[82:83], v9 offset:512
    ds_read_b64_tr_b16 v[84:85], v10 offset:0
    ds_read_b64_tr_b16 v[86:87], v10 offset:512
    ds_read_b64_tr_b16 v[88:89], v9 offset:2048
    ds_read_b64_tr_b16 v[90:91], v9 offset:2560
    ds_read_b64_tr_b16 v[92:93], v10 offset:2048
    ds_read_b64_tr_b16 v[94:95], v10 offset:2560
    s_waitcnt vmcnt(14) lgkmcnt(4)
    v_mfma_f32_32x32x16_bf16 v[16:31], v[80:83], v[96:99], 0
    v_mfma_f32_32x32x16_bf16 v[32:47], v[80:83], v[100:103], 0
    s_add_u32 s35, s35, 131072
    buffer_load_dwordx4 v[160:163], v4, s[20:23], s35 offen offset:0 sc1
    buffer_load_dwordx4 v[164:167], v4, s[20:23], s35 offen offset:2048 sc1
    v_mfma_f32_32x32x16_bf16 v[48:63], v[84:87], v[96:99], 0
    v_mfma_f32_32x32x16_bf16 v[64:79], v[84:87], v[100:103], 0
    ds_read_b64_tr_b16 v[80:81], v9 offset:4096
    ds_read_b64_tr_b16 v[82:83], v9 offset:4608
    ds_read_b64_tr_b16 v[84:85], v10 offset:4096
    ds_read_b64_tr_b16 v[86:87], v10 offset:4608
    s_waitcnt vmcnt(14) lgkmcnt(4)
    v_mfma_f32_32x32x16_bf16 v[16:31], v[88:91], v[104:107], v[16:31]
    v_mfma_f32_32x32x16_bf16 v[32:47], v[88:91], v[108:111], v[32:47]
    buffer_load_dwordx4 v[168:171], v4, s[20:23], s35 offen offset:1024 sc1
    buffer_load_dwordx4 v[172:175], v4, s[20:23], s35 offen offset:3072 sc1
    v_mfma_f32_32x32x16_bf16 v[48:63], v[92:95], v[104:107], v[48:63]
    v_mfma_f32_32x32x16_bf16 v[64:79], v[92:95], v[108:111], v[64:79]
    ds_read_b64_tr_b16 v[88:89], v9 offset:6144
    ds_read_b64_tr_b16 v[90:91], v9 offset:6656
    ds_read_b64_tr_b16 v[92:93], v10 offset:6144
    ds_read_b64_tr_b16 v[94:95], v10 offset:6656
    s_waitcnt vmcnt(14) lgkmcnt(4)
    v_mfma_f32_32x32x16_bf16 v[16:31], v[80:83], v[112:115], v[16:31]
    v_mfma_f32_32x32x16_bf16 v[32:47], v[80:83], v[116:119], v[32:47]
    s_add_u32 s35, s35, 131072
    buffer_load_dwordx4 v[176:179], v4, s[20:23], s35 offen offset:0 sc1
    buffer_load_dwordx4 v[180:183], v4, s[20:23], s35 offen offset:2048 sc1
    v_mfma_f32_32x32x16_bf16 v[48:63], v[84:87], v[112:115], v[48:63]
    v_mfma_f32_32x32x16_bf16 v[64:79], v[84:87], v[116:119], v[64:79]
    ds_read_b64_tr_b16 v[80:81], v9 offset:8192
    ds_read_b64_tr_b16 v[82:83], v9 offset:8704
    ds_read_b64_tr_b16 v[84:85], v10 offset:8192
    ds_read_b64_tr_b16 v[86:87], v10 offset:8704
    s_waitcnt vmcnt(14) lgkmcnt(4)
    v_mfma_f32_32x32x16_bf16 v[16:31], v[88:91], v[120:123], v[16:31]
    v_mfma_f32_32x32x16_bf16 v[32:47], v[88:91], v[124:127], v[32:47]
    buffer_load_dwordx4 v[184:187], v4, s[20:23], s35 offen offset:1024 sc1
    buffer_load_dwordx4 v[188:191], v4, s[20:23], s35 offen offset:3072 sc1
    v_mfma_f32_32x32x16_bf16 v[48:63], v[92:95], v[120:123], v[48:63]
    v_mfma_f32_32x32x16_bf16 v[64:79], v[92:95], v[124:127], v[64:79]
    ds_read_b64_tr_b16 v[88:89], v9 offset:10240
    ds_read_b64_tr_b16 v[90:91], v9 offset:10752
    ds_read_b64_tr_b16 v[92:93], v10 offset:10240
    ds_read_b64_tr_b16 v[94:95], v10 offset:10752
    s_waitcnt vmcnt(14) lgkmcnt(4)
    v_mfma_f32_32x32x16_bf16 v[16:31], v[80:83], v[128:131], v[16:31]
    v_mfma_f32_32x32x16_bf16 v[32:47], v[80:83], v[132:135], v[32:47]
    s_add_u32 s35, s35, 131072
    buffer_load_dwordx4 v[192:195], v4, s[20:23], s35 offen offset:0 sc1
    buffer_load_dwordx4 v[196:199], v4, s[20:23], s35 offen offset:2048 sc1
    v_mfma_f32_32x32x16_bf16 v[48:63], v[84:87], v[128:131], v[48:63]
    v_mfma_f32_32x32x16_bf16 v[64:79], v[84:87], v[132:135], v[64:79]
    ds_read_b64_tr_b16 v[80:81], v9 offset:12288
    ds_read_b64_tr_b16 v[82:83], v9 offset:12800
    ds_read_b64_tr_b16 v[84:85], v10 offset:12288
    ds_read_b64_tr_b16 v[86:87], v10 offset:12800
    s_waitcnt vmcnt(14) lgkmcnt(4)
    v_mfma_f32_32x32x16_bf16 v[16:31], v[88:91], v[136:139], v[16:31]
    v_mfma_f32_32x32x16_bf16 v[32:47], v[88:91], v[140:143], v[32:47]
    buffer_load_dwordx4 v[200:203], v4, s[20:23], s35 offen offset:1024 sc1
    buffer_load_dwordx4 v[204:207], v4, s[20:23], s35 offen offset:3072 sc1
    v_mfma_f32_32x32x16_bf16 v[48:63], v[92:95], v[136:139], v[48:63]
    v_mfma_f32_32x32x16_bf16 v[64:79], v[92:95], v[140:143], v[64:79]
    ds_read_b64_tr_b16 v[88:89], v9 offset:14336
    ds_read_b64_tr_b16 v[90:91], v9 offset:14848
    ds_read_b64_tr_b16 v[92:93], v10 offset:14336
    ds_read_b64_tr_b16 v[94:95], v10 offset:14848
    s_waitcnt vmcnt(14) lgkmcnt(4)
    v_mfma_f32_32x32x16_bf16 v[16:31], v[80:83], v[144:147], v[16:31]
    v_mfma_f32_32x32x16_bf16 v[32:47], v[80:83], v[148:151], v[32:47]
    v_mfma_f32_32x32x16_bf16 v[48:63], v[84:87], v[144:147], v[48:63]
    v_mfma_f32_32x32x16_bf16 v[64:79], v[84:87], v[148:151], v[64:79]
    ds_read_b64_tr_b16 v[80:81], v9 offset:16384
    ds_read_b64_tr_b16 v[82:83], v9 offset:16896
    ds_read_b64_tr_b16 v[84:85], v10 offset:16384
    ds_read_b64_tr_b16 v[86:87], v10 offset:16896
    s_waitcnt vmcnt(12) lgkmcnt(4)
    v_mfma_f32_32x32x16_bf16 v[16:31], v[88:91], v[152:155], v[16:31]
    v_mfma_f32_32x32x16_bf16 v[32:47], v[88:91], v[156:159], v[32:47]
    v_mfma_f32_32x32x16_bf16 v[48:63], v[92:95], v[152:155], v[48:63]
    v_mfma_f32_32x32x16_bf16 v[64:79], v[92:95], v[156:159], v[64:79]
    ds_read_b64_tr_b16 v[88:89], v9 offset:18432
    ds_read_b64_tr_b16 v[90:91], v9 offset:18944
    ds_read_b64_tr_b16 v[92:93], v10 offset:18432
    ds_read_b64_tr_b16 v[94:95], v10 offset:18944
    s_waitcnt vmcnt(10) lgkmcnt(4)
    v_mfma_f32_32x32x16_bf16 v[16:31], v[80:83], v[160:163], v[16:31]
    v_mfma_f32_32x32x16_bf16 v[32:47], v[80:83], v[164:167], v[32:47]
    v_mfma_f32_32x32x16_bf16 v[48:63], v[84:87], v[160:163], v[48:63]
    v_mfma_f32_32x32x16_bf16 v[64:79], v[84:87], v[164:167], v[64:79]
    ds_read_b64_tr_b16 v[80:81], v9 offset:20480
    ds_read_b64_tr_b16 v[82:83], v9 offset:20992
    ds_read_b64_tr_b16 v[84:85], v10 offset:20480
    ds_read_b64_tr_b16 v[86:87], v10 offset:20992
    s_waitcnt vmcnt(8) lgkmcnt(4)
    v_mfma_f32_32x32x16_bf16 v[16:31], v[88:91], v[168:171], v[16:31]
    v_mfma_f32_32x32x16_bf16 v[32:47], v[88:91], v[172:175], v[32:47]
    v_mfma_f32_32x32x16_bf16 v[48:63], v[92:95], v[168:171], v[48:63]
    v_mfma_f32_32x32x16_bf16 v[64:79], v[92:95], v[172:175], v[64:79]
    ds_read_b64_tr_b16 v[88:89], v9 offset:22528
    ds_read_b64_tr_b16 v[90:91], v9 offset:23040
    ds_read_b64_tr_b16 v[92:93], v10 offset:22528
    ds_read_b64_tr_b16 v[94:95], v10 offset:23040
    s_waitcnt vmcnt(6) lgkmcnt(4)
    v_mfma_f32_32x32x16_bf16 v[16:31], v[80:83], v[176:179], v[16:31]
    v_mfma_f32_32x32x16_bf16 v[32:47], v[80:83], v[180:183], v[32:47]
    v_mfma_f32_32x32x16_bf16 v[48:63], v[84:87], v[176:179], v[48:63]
    v_mfma_f32_32x32x16_bf16 v[64:79], v[84:87], v[180:183], v[64:79]
    ds_read_b64_tr_b16 v[80:81], v9 offset:24576
    ds_read_b64_tr_b16 v[82:83], v9 offset:25088
    ds_read_b64_tr_b16 v[84:85], v10 offset:24576
    ds_read_b64_tr_b16 v[86:87], v10 offset:25088
    s_waitcnt vmcnt(4) lgkmcnt(4)
    v_mfma_f32_32x32x16_bf16 v[16:31], v[88:91], v[184:187], v[16:31]
    v_mfma_f32_32x32x16_bf16 v[32:47], v[88:91], v[188:191], v[32:47]
    v_mfma_f32_32x32x16_bf16 v[48:63], v[92:95], v[184:187], v[48:63]
    v_mfma_f32_32x32x16_bf16 v[64:79], v[92:95], v[188:191], v[64:79]
    ds_read_b64_tr_b16 v[88:89], v9 offset:26624
    ds_read_b64_tr_b16 v[90:91], v9 offset:27136
    ds_read_b64_tr_b16 v[92:93], v10 offset:26624
    ds_read_b64_tr_b16 v[94:95], v10 offset:27136
    s_waitcnt vmcnt(2) lgkmcnt(4)
    v_mfma_f32_32x32x16_bf16 v[16:31], v[80:83], v[192:195], v[16:31]
    v_mfma_f32_32x32x16_bf16 v[32:47], v[80:83], v[196:199], v[32:47]
    v_mfma_f32_32x32x16_bf16 v[48:63], v[84:87], v[192:195], v[48:63]
    v_mfma_f32_32x32x16_bf16 v[64:79], v[84:87], v[196:199], v[64:79]
    s_waitcnt vmcnt(0) lgkmcnt(0)
    v_mfma_f32_32x32x16_bf16 v[16:31], v[88:91], v[200:203], v[16:31]
    v_mfma_f32_32x32x16_bf16 v[32:47], v[88:91], v[204:207], v[32:47]
    v_mfma_f32_32x32x16_bf16 v[48:63], v[92:95], v[200:203], v[48:63]
    v_mfma_f32_32x32x16_bf16 v[64:79], v[92:95], v[204:207], v[64:79]
    s_nop 8
    ds_write_b128 v5, v[16:19] offset:0
    ds_write_b128 v5, v[20:23] offset:1024
    ds_write_b128 v5, v[24:27] offset:2048
    ds_write_b128 v5, v[28:31] offset:3072
    ds_write_b128 v5, v[32:35] offset:4096
    ds_write_b128 v5, v[36:39] offset:5120
    ds_write_b128 v5, v[40:43] offset:6144
    ds_write_b128 v5, v[44:47] offset:7168
    ds_write_b128 v5, v[48:51] offset:8192
    ds_write_b128 v5, v[52:55] offset:9216
    ds_write_b128 v5, v[56:59] offset:10240
    ds_write_b128 v5, v[60:63] offset:11264
    s_waitcnt lgkmcnt(8)
    ds_write_b128 v5, v[64:67] offset:12288
    ds_write_b128 v5, v[68:71] offset:13312
    ds_write_b128 v5, v[72:75] offset:14336
    ds_write_b128 v5, v[76:79] offset:15360
    s_waitcnt lgkmcnt(0)
    s_barrier
    s_endpgm
F_H:
    s_load_dwordx4 s[4:7], s[0:1], 8
    s_load_dwordx2 s[62:63], s[0:1], 24
    s_load_dwordx4 s[64:67], s[0:1], 32
    s_load_dwordx2 s[92:93], s[0:1], 0
    s_load_dwordx4 s[96:99], s[0:1], 80
    s_load_dwordx2 s[94:95], s[0:1], 64
    s_memrealtime s[60:61]
    s_sub_u32 s38, s24, 4
    s_lshr_b32 s39, s38, 1
    s_and_b32 s27, s38, 1
    s_lshl_b32 s40, s2, 1
    s_add_u32 s40, s40, s39
    s_mul_i32 s41, s39, 16640
    s_add_u32 s41, s41, 49152
    s_mul_i32 s42, s38, 4608
    s_add_u32 s42, s42, 82432
    s_and_b32 s32, s28, 1
    s_mul_i32 s32, s32, 28
    s_add_u32 s32, s32, s29
    s_lshr_b32 s25, s32, 3
    s_and_b32 s32, s32, 7
    s_lshr_b32 s26, s28, 1
    s_lshl_b32 s26, s26, 3
    s_add_u32 s26, s26, s32
    s_mul_i32 s46, s2, 293
    s_lshr_b32 s46, s46, 11
    s_mul_i32 s47, s46, 7
    s_sub_u32 s47, s2, s47
    s_lshl_b32 s47, s47, 2
    s_add_u32 s47, s47, s38
    s_lshl_b32 s33, s40, 12
    s_lshl_b32 s53, s38, 11
    s_add_u32 s53, s53, 102400
    s_waitcnt lgkmcnt(0)
    s_add_u32 s64, s64, s33
    s_addc_u32 s65, s65, 0
    s_mov_b32 s20, s10
    s_and_b32 s21, s11, 0xffff
    s_mov_b32 s22, 22544384
    s_mov_b32 s23, 0x20000
    s_or_b32 s33, s2, s38
    s_cmp_lg_u32 s33, 0
    s_cbranch_scc1 F_nononce
    v_mov_b32 v3, 0
    s_or_b32 s61, s61, 0x80000000
    v_mov_b32 v12, s60
    v_mov_b32 v13, s61
    global_store_dwordx2 v3, v[12:13], s[8:9] sc1
F_nononce:
    v_lshlrev_b32 v2, 4, v1
    s_lshl_b32 s34, s27, 11
    v_add_u32 v3, s34, v2
    v_and_b32 v4, 1, v1
    v_lshlrev_b32 v4, 4, v4
    v_add_u32 v5, 4294967264, v4
    v_add_u32 v6, 4294967280, v4
    v_lshlrev_b32 v8, 3, v1
    v_add_u32 v8, s42, v8
    v_and_b32 v9, 15, v1
    v_lshrrev_b32 v10, 4, v1
    v_add_u32 v11, 1, v9
    v_and_b32 v12, 3, v11
    v_mul_u32_u24 v12, 4160, v12
    v_and_b32 v11, 0x1c, v11
    v_lshl_add_u32 v12, v11, 1, v12
    v_lshl_add_u32 v12, v10, 4, v12
    s_lshl_b32 s35, s27, 8
    s_add_u32 s36, s41, s35
    v_add_u32 v50, s36, v12
    v_lshlrev_b32 v12, 5, v9
    v_lshlrev_b32 v13, 4, v10
    v_sub_u32 v13, v13, v12
    s_add_u32 s36, s42, s35
    s_add_u32 s36, s36, 480
    v_add_u32 v51, s36, v13
    s_add_u32 s36, s41, 32
    v_add_u32 v52, s36, v3
    v_add_u32 v53, s41, v4
    v_add_u32 v54, s42, v2
    s_xor_b32 s35, s38, 1
    s_mul_i32 s35, s35, 4608
    s_add_u32 s35, s35, 82432
    v_add_u32 v55, s35, v2
    v_lshlrev_b32 v56, 5, v9
    v_lshl_add_u32 v56, v10, 3, v56
    s_sub_u32 s36, s42, s34
    s_add_u32 s36, s36, 2552
    v_sub_u32 v57, s36, v56
    v_add_u32 v56, s53, v56
    s_mul_i32 s44, s40, 4224
    s_add_u32 s44, s44, 16777216
    s_add_u32 s43, s44, s34
    s_mul_i32 s48, s46, 57344
    s_lshl_b32 s49, s47, 5
    s_add_u32 s48, s48, s49
    v_and_b32 v12, 7, v1
    v_lshrrev_b32 v13, 3, v1
    v_mul_u32_u24 v14, 7168, v13
    v_lshl_add_u32 v14, v12, 2, v14
    v_add_u32 v16, s48, v14
    v_add_u32 v17, 3584, v16
    v_add_u32 v18, 4294964608, v16
    v_add_u32 v19, 4294965504, v16
    v_add_u32 v20, 4294966400, v16
    v_lshlrev_b32 v21, 4, v12
    s_lshl_b32 s49, s47, 7
    v_sub_u32 v22, 7, v13
    v_xor_b32 v22, v22, v12
    v_lshlrev_b32 v22, 4, v22
    v_lshl_add_u32 v22, v12, 8, v22
    v_add_u32 v22, s53, v22
    v_lshrrev_b32 v23, 4, v1
    v_xor_b32 v23, v23, v12
    v_lshlrev_b32 v23, 4, v23
    v_lshl_add_u32 v23, v13, 7, v23
    v_add_u32 v23, s53, v23
    v_xor_b32 v24, 64, v23
    v_mul_u32_u24 v25, 4224, v13
    v_lshl_add_u32 v25, v12, 4, v25
    s_mul_i32 s54, s47, 67584
    s_lshl_b32 s55, s46, 7
    s_sub_u32 s54, s54, s55
    s_add_u32 s54, s54, 16781184
    s_add_u32 s55, s54, 33792
    s_lshl_b32 s56, s47, 5
    s_add_u32 s56, s56, s46
    s_lshl_b32 s56, s56, 6
    s_add_u32 s56, s56, 21561344
    s_lshr_b32 s57, s40, 4
    s_lshl_b32 s57, s57, 11
    s_add_u32 s57, s57, 21561344
    v_and_b32 v31, 31, v1
    v_lshlrev_b32 v31, 6, v31
    v_mov_b32 v26, 1
    v_mov_b32 v27, 0
    v_mov_b32 v30, 157696
    ds_write_b32 v30, v27
    s_lshl_b32 s33, s38, 2
    s_add_u32 s33, s33, 157712
    v_mov_b32 v61, s33
    ds_write_b32 v61, v27
    s_barrier
    s_barrier
    s_barrier
    s_barrier
    s_barrier
    s_barrier
    s_barrier
    s_mov_b32 s12, s62
    s_and_b32 s13, s63, 0xffff
    s_mov_b32 s14, 3584
    s_mov_b32 s15, 0x20000
    buffer_load_dwordx4 v[160:163], v21, s[12:15], s49 offen
    s_mov_b32 s12, s4
    s_and_b32 s13, s5, 0xffff
    s_mov_b32 s14, 1835008
    s_mov_b32 s15, 0x20000
    buffer_load_dword v140, v18, s[12:15], 0 offen
    buffer_load_dword v141, v19, s[12:15], 0 offen
    buffer_load_dword v142, v20, s[12:15], 0 offen
    buffer_load_dword v143, v16, s[12:15], 0 offen offset:0
    buffer_load_dword v144, v16, s[12:15], 0 offen offset:896
    buffer_load_dword v145, v16, s[12:15], 0 offen offset:1792
    buffer_load_dword v146, v16, s[12:15], 0 offen offset:2688
    buffer_load_dword v147, v17, s[12:15], 0 offen offset:0
    buffer_load_dword v148, v17, s[12:15], 0 offen offset:896
    buffer_load_dword v149, v17, s[12:15], 0 offen offset:1792
    buffer_load_dword v150, v17, s[12:15], 0 offen offset:2688
    s_mov_b32 s12, s6
    s_and_b32 s13, s7, 0xffff
    s_mov_b32 s14, 1835008
    s_mov_b32 s15, 0x20000
    buffer_load_dword v152, v16, s[12:15], 0 offen offset:0
    buffer_load_dword v153, v16, s[12:15], 0 offen offset:896
    buffer_load_dword v154, v16, s[12:15], 0 offen offset:1792
    buffer_load_dword v155, v16, s[12:15], 0 offen offset:2688
    buffer_load_dword v156, v17, s[12:15], 0 offen offset:0
    buffer_load_dword v157, v17, s[12:15], 0 offen offset:896
    buffer_load_dword v158, v17, s[12:15], 0 offen offset:1792
    buffer_load_dword v159, v17, s[12:15], 0 offen offset:2688
    global_load_dwordx2 v[58:59], v27, s[8:9] sc1
    s_mov_b32 s12, s64
    s_and_b32 s13, s65, 0xffff
    s_mov_b32 s14, 4096
    s_mov_b32 s15, 0x20000
    s_mov_b32 s16, s66
    s_and_b32 s17, s67, 0xffff
    s_mov_b32 s18, 896
    s_mov_b32 s19, 0x20000
    buffer_load_dwordx4 v[64:67], v3, s[12:15], 0 offen offset:0
    buffer_load_dwordx2 v[68:69], v3, s[12:15], 0 offen offset:16
    buffer_load_dwordx4 v[72:75], v3, s[12:15], 0 offen offset:1024
    buffer_load_dwordx2 v[76:77], v3, s[12:15], 0 offen offset:1040
    buffer_load_dwordx4 v[80:83], v5, s[12:15], 0 offen
    buffer_load_dwordx2 v[84:85], v6, s[12:15], 0 offen
    s_lshl_b32 s35, s40, 1
    v_mov_b32 v7, s35
    buffer_load_ushort v60, v7, s[16:19], 0 offen
    s_barrier
    s_barrier
    s_setprio 2
    s_waitcnt vmcnt(7)
    v_lshlrev_b32 v164, 16, v160
    v_and_b32 v166, 0xffff0000, v160
    v_lshlrev_b32 v168, 16, v161
    v_and_b32 v170, 0xffff0000, v161
    v_lshlrev_b32 v165, 16, v162
    v_and_b32 v167, 0xffff0000, v162
    v_lshlrev_b32 v169, 16, v163
    v_and_b32 v171, 0xffff0000, v163
    v_lshlrev_b32 v184, 16, v140
    v_and_b32 v185, 0xffff0000, v140
    v_lshlrev_b32 v186, 16, v141
    v_and_b32 v187, 0xffff0000, v141
    v_lshlrev_b32 v188, 16, v142
    v_and_b32 v189, 0xffff0000, v142
    v_lshlrev_b32 v190, 16, v143
    v_and_b32 v191, 0xffff0000, v143
    v_mul_f32 v172, v184, v170
    v_mul_f32 v173, v185, v171
    v_fmac_f32 v172, v186, v168
    v_fmac_f32 v173, v187, v169
    v_fmac_f32 v172, v188, v166
    v_fmac_f32 v173, v189, v167
    v_fmac_f32 v172, v190, v164
    v_fmac_f32 v173, v191, v165
    v_lshlrev_b32 v184, 16, v152
    v_and_b32 v185, 0xffff0000, v152
    v_mul_f32 v172, v172, v184
    v_mul_f32 v173, v173, v185
    v_lshlrev_b32 v184, 16, v144
    v_and_b32 v185, 0xffff0000, v144
    v_mul_f32 v174, v186, v170
    v_mul_f32 v175, v187, v171
    v_fmac_f32 v174, v188, v168
    v_fmac_f32 v175, v189, v169
    v_fmac_f32 v174, v190, v166
    v_fmac_f32 v175, v191, v167
    v_fmac_f32 v174, v184, v164
    v_fmac_f32 v175, v185, v165
    v_lshlrev_b32 v186, 16, v153
    v_and_b32 v187, 0xffff0000, v153
    v_mul_f32 v174, v174, v186
    v_mul_f32 v175, v175, v187
    v_cvt_pk_bf16_f32 v179, v174, v172
    v_cvt_pk_bf16_f32 v183, v175, v173
    v_lshlrev_b32 v186, 16, v145
    v_and_b32 v187, 0xffff0000, v145
    v_mul_f32 v172, v188, v170
    v_mul_f32 v173, v189, v171
    v_fmac_f32 v172, v190, v168
    v_fmac_f32 v173, v191, v169
    v_fmac_f32 v172, v184, v166
    v_fmac_f32 v173, v185, v167
    v_fmac_f32 v172, v186, v164
    v_fmac_f32 v173, v187, v165
    v_lshlrev_b32 v188, 16, v154
    v_and_b32 v189, 0xffff0000, v154
    v_mul_f32 v172, v172, v188
    v_mul_f32 v173, v173, v189
    v_lshlrev_b32 v188, 16, v146
    v_and_b32 v189, 0xffff0000, v146
    v_mul_f32 v174, v190, v170
    v_mul_f32 v175, v191, v171
    v_fmac_f32 v174, v184, v168
    v_fmac_f32 v175, v185, v169
    v_fmac_f32 v174, v186, v166
    v_fmac_f32 v175, v187, v167
    v_fmac_f32 v174, v188, v164
    v_fmac_f32 v175, v189, v165
    v_lshlrev_b32 v190, 16, v155
    v_and_b32 v191, 0xffff0000, v155
    v_mul_f32 v174, v174, v190
    v_mul_f32 v175, v175, v191
    v_cvt_pk_bf16_f32 v178, v174, v172
    v_cvt_pk_bf16_f32 v182, v175, v173
    v_lshlrev_b32 v190, 16, v147
    v_and_b32 v191, 0xffff0000, v147
    v_mul_f32 v172, v184, v170
    v_mul_f32 v173, v185, v171
    v_fmac_f32 v172, v186, v168
    v_fmac_f32 v173, v187, v169
    v_fmac_f32 v172, v188, v166
    v_fmac_f32 v173, v189, v167
    v_fmac_f32 v172, v190, v164
    v_fmac_f32 v173, v191, v165
    v_lshlrev_b32 v184, 16, v156
    v_and_b32 v185, 0xffff0000, v156
    v_mul_f32 v172, v172, v184
    v_mul_f32 v173, v173, v185
    v_lshlrev_b32 v184, 16, v148
    v_and_b32 v185, 0xffff0000, v148
    v_mul_f32 v174, v186, v170
    v_mul_f32 v175, v187, v171
    v_fmac_f32 v174, v188, v168
    v_fmac_f32 v175, v189, v169
    v_fmac_f32 v174, v190, v166
    v_fmac_f32 v175, v191, v167
    v_fmac_f32 v174, v184, v164
    v_fmac_f32 v175, v185, v165
    v_lshlrev_b32 v186, 16, v157
    v_and_b32 v187, 0xffff0000, v157
    v_mul_f32 v174, v174, v186
    v_mul_f32 v175, v175, v187
    v_cvt_pk_bf16_f32 v177, v174, v172
    v_cvt_pk_bf16_f32 v181, v175, v173
    v_lshlrev_b32 v186, 16, v149
    v_and_b32 v187, 0xffff0000, v149
    v_mul_f32 v172, v188, v170
    v_mul_f32 v173, v189, v171
    v_fmac_f32 v172, v190, v168
    v_fmac_f32 v173, v191, v169
    v_fmac_f32 v172, v184, v166
    v_fmac_f32 v173, v185, v167
    v_fmac_f32 v172, v186, v164
    v_fmac_f32 v173, v187, v165
    v_lshlrev_b32 v188, 16, v158
    v_and_b32 v189, 0xffff0000, v158
    v_mul_f32 v172, v172, v188
    v_mul_f32 v173, v173, v189
    v_lshlrev_b32 v188, 16, v150
    v_and_b32 v189, 0xffff0000, v150
    v_mul_f32 v174, v190, v170
    v_mul_f32 v175, v191, v171
    v_fmac_f32 v174, v184, v168
    v_fmac_f32 v175, v185, v169
    v_fmac_f32 v174, v186, v166
    v_fmac_f32 v175, v187, v167
    v_fmac_f32 v174, v188, v164
    v_fmac_f32 v175, v189, v165
    v_lshlrev_b32 v190, 16, v159
    v_and_b32 v191, 0xffff0000, v159
    v_mul_f32 v174, v174, v190
    v_mul_f32 v175, v175, v191
    v_cvt_pk_bf16_f32 v176, v174, v172
    v_cvt_pk_bf16_f32 v180, v175, v173
    ds_write_b128 v22, v[176:179]
    ds_write_b128 v22, v[180:183] offset:128
    ds_read_b128 v[140:143], v23
    ds_read_b128 v[144:147], v24 offset:1024
    s_waitcnt lgkmcnt(0)
    buffer_store_dwordx4 v[140:143], v25, s[20:23], s54 offen sc1
    buffer_store_dwordx4 v[144:147], v25, s[20:23], s55 offen sc1
    s_waitcnt vmcnt(2)
    v_alignbit_b32 v96, v65, v64, 16
    v_mov_b32 v100, v65
    v_alignbit_b32 v104, v66, v65, 16
    v_alignbit_b32 v97, v66, v65, 16
    v_mov_b32 v101, v66
    v_alignbit_b32 v105, v67, v66, 16
    v_alignbit_b32 v98, v67, v66, 16
    v_mov_b32 v102, v67
    v_alignbit_b32 v106, v68, v67, 16
    v_alignbit_b32 v99, v68, v67, 16
    v_mov_b32 v103, v68
    v_alignbit_b32 v107, v69, v68, 16
    ds_write_b128 v52, v[64:67] offset:0
    ds_write_b128 v52, v[96:99] offset:4160
    ds_write_b128 v52, v[100:103] offset:8320
    ds_write_b128 v52, v[104:107] offset:12480
    v_alignbit_b32 v108, v73, v72, 16
    v_mov_b32 v112, v73
    v_alignbit_b32 v116, v74, v73, 16
    v_alignbit_b32 v109, v74, v73, 16
    v_mov_b32 v113, v74
    v_alignbit_b32 v117, v75, v74, 16
    v_alignbit_b32 v110, v75, v74, 16
    v_mov_b32 v114, v75
    v_alignbit_b32 v118, v76, v75, 16
    v_alignbit_b32 v111, v76, v75, 16
    v_mov_b32 v115, v76
    v_alignbit_b32 v119, v77, v76, 16
    ds_write_b128 v52, v[72:75] offset:1024
    ds_write_b128 v52, v[108:111] offset:5184
    ds_write_b128 v52, v[112:115] offset:9344
    ds_write_b128 v52, v[116:119] offset:13504
    v_alignbit_b32 v120, v81, v80, 16
    v_mov_b32 v124, v81
    v_alignbit_b32 v128, v82, v81, 16
    v_alignbit_b32 v121, v82, v81, 16
    v_mov_b32 v125, v82
    v_alignbit_b32 v129, v83, v82, 16
    v_alignbit_b32 v122, v83, v82, 16
    v_mov_b32 v126, v83
    v_alignbit_b32 v130, v84, v83, 16
    v_alignbit_b32 v123, v84, v83, 16
    v_mov_b32 v127, v84
    v_alignbit_b32 v131, v85, v84, 16
    ds_write_b128 v53, v[80:83] offset:0
    ds_write_b128 v53, v[120:123] offset:4160
    ds_write_b128 v53, v[124:127] offset:8320
    ds_write_b128 v53, v[128:131] offset:12480
    v_mov_b32 v28, 0
    v_mov_b32 v29, 0
    ds_write_b64 v8, v[28:29] offset:4096
    s_mov_b32 s50, 0
F_n2_r:
    v_readfirstlane_b32 s51, v59
    s_nop 1
    s_cmp_lg_u32 s51, 0
    s_cbranch_scc1 F_n2_ok
    s_add_u32 s50, s50, 1
    s_cmp_gt_u32 s50, 0x100000
    s_cbranch_scc1 F_n2_ok
    s_sleep 1
    v_mov_b32 v27, 0
    global_load_dwordx2 v[58:59], v27, s[8:9] sc1
    s_waitcnt vmcnt(0)
    s_branch F_n2_r
F_n2_ok:
    s_waitcnt vmcnt(0)
    s_mov_b64 exec, 1
    buffer_store_dwordx2 v[58:59], v27, s[20:23], s56 offen sc1
    s_mov_b64 exec, -1
    s_mov_b32 s16, s94
    s_and_b32 s17, s95, 0xffff
    s_mov_b32 s18, 8388608
    s_mov_b32 s19, 0x20000
    v_lshrrev_b32 v11, 3, v1
    v_and_b32 v12, 7, v1
    v_lshrrev_b32 v13, 4, v1
    v_lshlrev_b32 v14, 12, v11
    v_xor_b32 v15, v12, v13
    v_lshl_add_u32 v48, v15, 4, v14
    v_xor_b32 v15, 4, v15
    v_lshl_add_u32 v49, v15, 4, v14
    v_add_u32 v49, 0x8000, v49
    s_lshl_b32 s59, s26, 2
    s_add_u32 s59, s59, s38
    s_lshl_b32 s59, s59, 16
    s_lshl_b32 s33, s38, 11
    v_add_u32 v62, s33, v2
    v_add_u32 v63, 114688, v62
    s_mov_b32 s12, s92
    s_and_b32 s13, s93, 0xffff
    s_mov_b32 s14, 1835008
    s_mov_b32 s15, 0x20000
    v_lshrrev_b32 v11, 2, v1
    v_mul_u32_u24 v11, 896, v11
    v_and_b32 v12, 3, v1
    v_lshl_add_u32 v11, v12, 4, v11
    s_lshl_b32 s35, s26, 1
    s_add_u32 s35, s35, s27
    s_mul_i32 s35, s35, 28672
    s_lshl_b32 s36, s25, 1
    s_add_u32 s36, s36, s39
    s_lshl_b32 s36, s36, 6
    s_add_u32 s35, s35, s36
    s_mul_i32 s100, s39, 49152
    s_lshl_b32 s36, s27, 11
    s_add_u32 s100, s100, s36
    s_add_u32 s100, s100, 110592
    s_mov_b32 m0, s100
    s_nop 0
    buffer_load_dwordx4 v11, s[12:15], s35 offen lds
    s_add_u32 s35, s35, 14336
    s_add_u32 m0, s100, 1024
    s_nop 0
    buffer_load_dwordx4 v11, s[12:15], s35 offen lds
    buffer_load_dwordx4 v[192:195], v48, s[16:19], s59 offen offset:3072
    buffer_load_dwordx4 v[196:199], v49, s[16:19], s59 offen offset:3072
    buffer_load_dwordx4 v[200:203], v48, s[16:19], s59 offen offset:3200
    buffer_load_dwordx4 v[204:207], v49, s[16:19], s59 offen offset:3200
    buffer_load_dwordx4 v[208:211], v48, s[16:19], s59 offen offset:3328
    buffer_load_dwordx4 v[212:215], v49, s[16:19], s59 offen offset:3328
    buffer_load_dwordx4 v[216:219], v48, s[16:19], s59 offen offset:3456
    buffer_load_dwordx4 v[220:223], v49, s[16:19], s59 offen offset:3456
    buffer_load_dwordx4 v[224:227], v48, s[16:19], s59 offen offset:3584
    buffer_load_dwordx4 v[228:231], v49, s[16:19], s59 offen offset:3584
    buffer_load_dwordx4 v[232:235], v48, s[16:19], s59 offen offset:3712
    buffer_load_dwordx4 v[236:239], v49, s[16:19], s59 offen offset:3712
    buffer_load_dwordx4 v[240:243], v48, s[16:19], s59 offen offset:3840
    buffer_load_dwordx4 v[244:247], v49, s[16:19], s59 offen offset:3840
    buffer_load_dwordx4 v[248:251], v48, s[16:19], s59 offen offset:3968
    buffer_load_dwordx4 v[252:255], v49, s[16:19], s59 offen offset:3968
    s_waitcnt lgkmcnt(0)
    s_setprio 0
    s_barrier
    s_cmp_lg_u32 s38, 0
    s_cbranch_scc1 F_lw
    s_mov_b32 s58, 0
F_u_p:
    buffer_load_dwordx2 v[28:29], v31, s[20:23], s57 offen sc1
    s_waitcnt vmcnt(0)
    v_xor_b32 v28, v28, v58
    v_xor_b32 v29, v29, v59
    v_or_b32 v28, v28, v29
    v_cmp_ne_u32 vcc, 0, v28
    s_nop 1
    s_cbranch_vccz F_u_ok
    s_add_u32 s58, s58, 1
    s_sleep 4
    s_cmp_gt_u32 s58, 0x100000
    s_cbranch_scc0 F_u_p
F_u_ok:
    ds_write_b32 v30, v26
F_lw:
    s_mov_b32 s58, 0
F_lwp:
    ds_read_b32 v28, v30
    s_waitcnt lgkmcnt(0)
    v_cmp_ne_u32 vcc, 1, v28
    s_nop 1
    s_cbranch_vccz F_lwok
    s_add_u32 s58, s58, 1
    s_sleep 2
    s_cmp_gt_u32 s58, 0x400000
    s_cbranch_scc0 F_lwp
F_lwok:
    s_mov_b32 m0, s42
    s_nop 0
    buffer_load_dwordx4 v2, s[20:23], s44 offen offset:0 sc1 lds
    buffer_load_dwordx4 v2, s[20:23], s44 offen offset:1024 sc1 lds
    buffer_load_dwordx4 v2, s[20:23], s44 offen offset:2048 sc1 lds
    buffer_load_dwordx4 v2, s[20:23], s44 offen offset:3072 sc1 lds
    ds_read_b64 v[64:65], v50 offset:0
    ds_read_b64 v[66:67], v50 offset:8
    ds_read_b64 v[68:69], v50 offset:512
    ds_read_b64 v[70:71], v50 offset:520
    ds_read_b64 v[72:73], v50 offset:1024
    ds_read_b64 v[74:75], v50 offset:1032
    ds_read_b64 v[76:77], v50 offset:1536
    ds_read_b64 v[78:79], v50 offset:1544
    ds_read_b64 v[80:81], v50 offset:2048
    ds_read_b64 v[82:83], v50 offset:2056
    ds_read_b64 v[84:85], v50 offset:2560
    ds_read_b64 v[86:87], v50 offset:2568
    s_waitcnt lgkmcnt(4)
    ds_read_b64 v[88:89], v50 offset:3072
    ds_read_b64 v[90:91], v50 offset:3080
    ds_read_b64 v[92:93], v50 offset:3584
    ds_read_b64 v[94:95], v50 offset:3592
    s_waitcnt vmcnt(0) lgkmcnt(0)
    ds_write_b32 v61, v26
    ds_read_b128 v[96:99], v51 offset:3584
    ds_read_b128 v[100:103], v51 offset:3072
    ds_read_b128 v[104:107], v51 offset:2560
    ds_read_b128 v[108:111], v51 offset:2048
    ds_read_b128 v[112:115], v51 offset:1536
    ds_read_b128 v[116:119], v51 offset:1024
    ds_read_b128 v[120:123], v51 offset:512
    ds_read_b128 v[124:127], v51 offset:0
    s_waitcnt lgkmcnt(0)
    v_mfma_f32_16x16x32_bf16 v[16:19], v[64:67], v[96:99], 0
    ds_read_b128 v[160:163], v51 offset:3648
    v_mfma_f32_16x16x32_bf16 v[20:23], v[64:67], v[100:103], 0
    ds_read_b64 v[128:129], v50 offset:64
    v_mfma_f32_16x16x32_bf16 v[24:27], v[64:67], v[104:107], 0
    ds_read_b64 v[130:131], v50 offset:72
    v_mfma_f32_16x16x32_bf16 v[28:31], v[64:67], v[108:111], 0
    ds_read_b128 v[164:167], v51 offset:3136
    v_mfma_f32_16x16x32_bf16 v[32:35], v[64:67], v[112:115], 0
    ds_read_b64 v[132:133], v50 offset:576
    v_mfma_f32_16x16x32_bf16 v[36:39], v[64:67], v[116:119], 0
    ds_read_b64 v[134:135], v50 offset:584
    v_mfma_f32_16x16x32_bf16 v[40:43], v[64:67], v[120:123], 0
    ds_read_b128 v[168:171], v51 offset:2624
    v_mfma_f32_16x16x32_bf16 v[44:47], v[64:67], v[124:127], 0
    ds_read_b64 v[136:137], v50 offset:1088
    v_mfma_f32_16x16x32_bf16 v[20:23], v[68:71], v[96:99], v[20:23]
    ds_read_b64 v[138:139], v50 offset:1096
    v_mfma_f32_16x16x32_bf16 v[24:27], v[68:71], v[100:103], v[24:27]
    ds_read_b128 v[172:175], v51 offset:2112
    v_mfma_f32_16x16x32_bf16 v[28:31], v[68:71], v[104:107], v[28:31]
    ds_read_b64 v[140:141], v50 offset:1600
    v_mfma_f32_16x16x32_bf16 v[32:35], v[68:71], v[108:111], v[32:35]
    ds_read_b64 v[142:143], v50 offset:1608
    s_waitcnt lgkmcnt(0)
    v_mfma_f32_16x16x32_bf16 v[36:39], v[68:71], v[112:115], v[36:39]
    ds_read_b128 v[176:179], v51 offset:1600
    v_mfma_f32_16x16x32_bf16 v[40:43], v[68:71], v[116:119], v[40:43]
    ds_read_b64 v[144:145], v50 offset:2112
    v_mfma_f32_16x16x32_bf16 v[44:47], v[68:71], v[120:123], v[44:47]
    ds_read_b64 v[146:147], v50 offset:2120
    v_mfma_f32_16x16x32_bf16 v[24:27], v[72:75], v[96:99], v[24:27]
    ds_read_b128 v[180:183], v51 offset:1088
    v_mfma_f32_16x16x32_bf16 v[28:31], v[72:75], v[100:103], v[28:31]
    ds_read_b64 v[148:149], v50 offset:2624
    v_mfma_f32_16x16x32_bf16 v[32:35], v[72:75], v[104:107], v[32:35]
    ds_read_b64 v[150:151], v50 offset:2632
    v_mfma_f32_16x16x32_bf16 v[36:39], v[72:75], v[108:111], v[36:39]
    ds_read_b128 v[184:187], v51 offset:576
    v_mfma_f32_16x16x32_bf16 v[40:43], v[72:75], v[112:115], v[40:43]
    ds_read_b64 v[152:153], v50 offset:3136
    v_mfma_f32_16x16x32_bf16 v[44:47], v[72:75], v[116:119], v[44:47]
    ds_read_b64 v[154:155], v50 offset:3144
    v_mfma_f32_16x16x32_bf16 v[28:31], v[76:79], v[96:99], v[28:31]
    ds_read_b128 v[188:191], v51 offset:64
    v_mfma_f32_16x16x32_bf16 v[32:35], v[76:79], v[100:103], v[32:35]
    ds_read_b64 v[156:157], v50 offset:3648
    v_mfma_f32_16x16x32_bf16 v[36:39], v[76:79], v[104:107], v[36:39]
    ds_read_b64 v[158:159], v50 offset:3656
    s_waitcnt lgkmcnt(0)
    v_mfma_f32_16x16x32_bf16 v[40:43], v[76:79], v[108:111], v[40:43]
    v_mfma_f32_16x16x32_bf16 v[44:47], v[76:79], v[112:115], v[44:47]
    v_mfma_f32_16x16x32_bf16 v[32:35], v[80:83], v[96:99], v[32:35]
    v_mfma_f32_16x16x32_bf16 v[36:39], v[80:83], v[100:103], v[36:39]
    v_mfma_f32_16x16x32_bf16 v[40:43], v[80:83], v[104:107], v[40:43]
    v_mfma_f32_16x16x32_bf16 v[44:47], v[80:83], v[108:111], v[44:47]
    v_mfma_f32_16x16x32_bf16 v[36:39], v[84:87], v[96:99], v[36:39]
    v_mfma_f32_16x16x32_bf16 v[40:43], v[84:87], v[100:103], v[40:43]
    v_mfma_f32_16x16x32_bf16 v[44:47], v[84:87], v[104:107], v[44:47]
    v_mfma_f32_16x16x32_bf16 v[40:43], v[88:91], v[96:99], v[40:43]
    v_mfma_f32_16x16x32_bf16 v[44:47], v[88:91], v[100:103], v[44:47]
    v_mfma_f32_16x16x32_bf16 v[44:47], v[92:95], v[96:99], v[44:47]
    s_waitcnt lgkmcnt(0)
    v_mfma_f32_16x16x32_bf16 v[16:19], v[128:131], v[160:163], v[16:19]
    ds_read_b128 v[96:99], v51 offset:3712
    v_mfma_f32_16x16x32_bf16 v[20:23], v[128:131], v[164:167], v[20:23]
    ds_read_b64 v[64:65], v50 offset:128
    v_mfma_f32_16x16x32_bf16 v[24:27], v[128:131], v[168:171], v[24:27]
    ds_read_b64 v[66:67], v50 offset:136
    v_mfma_f32_16x16x32_bf16 v[28:31], v[128:131], v[172:175], v[28:31]
    ds_read_b128 v[100:103], v51 offset:3200
    v_mfma_f32_16x16x32_bf16 v[32:35], v[128:131], v[176:179], v[32:35]
    ds_read_b64 v[68:69], v50 offset:640
    v_mfma_f32_16x16x32_bf16 v[36:39], v[128:131], v[180:183], v[36:39]
    ds_read_b64 v[70:71], v50 offset:648
    v_mfma_f32_16x16x32_bf16 v[40:43], v[128:131], v[184:187], v[40:43]
    ds_read_b128 v[104:107], v51 offset:2688
    v_mfma_f32_16x16x32_bf16 v[44:47], v[128:131], v[188:191], v[44:47]
    ds_read_b64 v[72:73], v50 offset:1152
    v_mfma_f32_16x16x32_bf16 v[20:23], v[132:135], v[160:163], v[20:23]
    ds_read_b64 v[74:75], v50 offset:1160
    v_mfma_f32_16x16x32_bf16 v[24:27], v[132:135], v[164:167], v[24:27]
    ds_read_b128 v[108:111], v51 offset:2176
    v_mfma_f32_16x16x32_bf16 v[28:31], v[132:135], v[168:171], v[28:31]
    ds_read_b64 v[76:77], v50 offset:1664
    v_mfma_f32_16x16x32_bf16 v[32:35], v[132:135], v[172:175], v[32:35]
    ds_read_b64 v[78:79], v50 offset:1672
    s_waitcnt lgkmcnt(0)
    v_mfma_f32_16x16x32_bf16 v[36:39], v[132:135], v[176:179], v[36:39]
    ds_read_b128 v[112:115], v51 offset:1664
    v_mfma_f32_16x16x32_bf16 v[40:43], v[132:135], v[180:183], v[40:43]
    ds_read_b64 v[80:81], v50 offset:2176
    v_mfma_f32_16x16x32_bf16 v[44:47], v[132:135], v[184:187], v[44:47]
    ds_read_b64 v[82:83], v50 offset:2184
    v_mfma_f32_16x16x32_bf16 v[24:27], v[136:139], v[160:163], v[24:27]
    ds_read_b128 v[116:119], v51 offset:1152
    v_mfma_f32_16x16x32_bf16 v[28:31], v[136:139], v[164:167], v[28:31]
    ds_read_b64 v[84:85], v50 offset:2688
    v_mfma_f32_16x16x32_bf16 v[32:35], v[136:139], v[168:171], v[32:35]
    ds_read_b64 v[86:87], v50 offset:2696
    v_mfma_f32_16x16x32_bf16 v[36:39], v[136:139], v[172:175], v[36:39]
    ds_read_b128 v[120:123], v51 offset:640
    v_mfma_f32_16x16x32_bf16 v[40:43], v[136:139], v[176:179], v[40:43]
    ds_read_b64 v[88:89], v50 offset:3200
    v_mfma_f32_16x16x32_bf16 v[44:47], v[136:139], v[180:183], v[44:47]
    ds_read_b64 v[90:91], v50 offset:3208
    v_mfma_f32_16x16x32_bf16 v[28:31], v[140:143], v[160:163], v[28:31]
    ds_read_b128 v[124:127], v51 offset:128
    v_mfma_f32_16x16x32_bf16 v[32:35], v[140:143], v[164:167], v[32:35]
    ds_read_b64 v[92:93], v50 offset:3712
    v_mfma_f32_16x16x32_bf16 v[36:39], v[140:143], v[168:171], v[36:39]
    ds_read_b64 v[94:95], v50 offset:3720
    s_waitcnt lgkmcnt(0)
    v_mfma_f32_16x16x32_bf16 v[40:43], v[140:143], v[172:175], v[40:43]
    v_mfma_f32_16x16x32_bf16 v[44:47], v[140:143], v[176:179], v[44:47]
    v_mfma_f32_16x16x32_bf16 v[32:35], v[144:147], v[160:163], v[32:35]
    v_mfma_f32_16x16x32_bf16 v[36:39], v[144:147], v[164:167], v[36:39]
    v_mfma_f32_16x16x32_bf16 v[40:43], v[144:147], v[168:171], v[40:43]
    v_mfma_f32_16x16x32_bf16 v[44:47], v[144:147], v[172:175], v[44:47]
    v_mfma_f32_16x16x32_bf16 v[36:39], v[148:151], v[160:163], v[36:39]
    v_mfma_f32_16x16x32_bf16 v[40:43], v[148:151], v[164:167], v[40:43]
    v_mfma_f32_16x16x32_bf16 v[44:47], v[148:151], v[168:171], v[44:47]
    v_mfma_f32_16x16x32_bf16 v[40:43], v[152:155], v[160:163], v[40:43]
    v_mfma_f32_16x16x32_bf16 v[44:47], v[152:155], v[164:167], v[44:47]
    v_mfma_f32_16x16x32_bf16 v[44:47], v[156:159], v[160:163], v[44:47]
    s_waitcnt lgkmcnt(0)
    v_mfma_f32_16x16x32_bf16 v[16:19], v[64:67], v[96:99], v[16:19]
    ds_read_b128 v[160:163], v51 offset:3776
    v_mfma_f32_16x16x32_bf16 v[20:23], v[64:67], v[100:103], v[20:23]
    ds_read_b64 v[128:129], v50 offset:192
    v_mfma_f32_16x16x32_bf16 v[24:27], v[64:67], v[104:107], v[24:27]
    ds_read_b64 v[130:131], v50 offset:200
    v_mfma_f32_16x16x32_bf16 v[28:31], v[64:67], v[108:111], v[28:31]
    ds_read_b128 v[164:167], v51 offset:3264
    v_mfma_f32_16x16x32_bf16 v[32:35], v[64:67], v[112:115], v[32:35]
    ds_read_b64 v[132:133], v50 offset:704
    v_mfma_f32_16x16x32_bf16 v[36:39], v[64:67], v[116:119], v[36:39]
    ds_read_b64 v[134:135], v50 offset:712
    v_mfma_f32_16x16x32_bf16 v[40:43], v[64:67], v[120:123], v[40:43]
    ds_read_b128 v[168:171], v51 offset:2752
    v_mfma_f32_16x16x32_bf16 v[44:47], v[64:67], v[124:127], v[44:47]
    ds_read_b64 v[136:137], v50 offset:1216
    v_mfma_f32_16x16x32_bf16 v[20:23], v[68:71], v[96:99], v[20:23]
    ds_read_b64 v[138:139], v50 offset:1224
    v_mfma_f32_16x16x32_bf16 v[24:27], v[68:71], v[100:103], v[24:27]
    ds_read_b128 v[172:175], v51 offset:2240
    v_mfma_f32_16x16x32_bf16 v[28:31], v[68:71], v[104:107], v[28:31]
    ds_read_b64 v[140:141], v50 offset:1728
    v_mfma_f32_16x16x32_bf16 v[32:35], v[68:71], v[108:111], v[32:35]
    ds_read_b64 v[142:143], v50 offset:1736
    s_waitcnt lgkmcnt(0)
    v_mfma_f32_16x16x32_bf16 v[36:39], v[68:71], v[112:115], v[36:39]
    ds_read_b128 v[176:179], v51 offset:1728
    v_mfma_f32_16x16x32_bf16 v[40:43], v[68:71], v[116:119], v[40:43]
    ds_read_b64 v[144:145], v50 offset:2240
    v_mfma_f32_16x16x32_bf16 v[44:47], v[68:71], v[120:123], v[44:47]
    ds_read_b64 v[146:147], v50 offset:2248
    v_mfma_f32_16x16x32_bf16 v[24:27], v[72:75], v[96:99], v[24:27]
    ds_read_b128 v[180:183], v51 offset:1216
    v_mfma_f32_16x16x32_bf16 v[28:31], v[72:75], v[100:103], v[28:31]
    ds_read_b64 v[148:149], v50 offset:2752
    v_mfma_f32_16x16x32_bf16 v[32:35], v[72:75], v[104:107], v[32:35]
    ds_read_b64 v[150:151], v50 offset:2760
    v_mfma_f32_16x16x32_bf16 v[36:39], v[72:75], v[108:111], v[36:39]
    ds_read_b128 v[184:187], v51 offset:704
    v_mfma_f32_16x16x32_bf16 v[40:43], v[72:75], v[112:115], v[40:43]
    ds_read_b64 v[152:153], v50 offset:3264
    v_mfma_f32_16x16x32_bf16 v[44:47], v[72:75], v[116:119], v[44:47]
    ds_read_b64 v[154:155], v50 offset:3272
    v_mfma_f32_16x16x32_bf16 v[28:31], v[76:79], v[96:99], v[28:31]
    ds_read_b128 v[188:191], v51 offset:192
    v_mfma_f32_16x16x32_bf16 v[32:35], v[76:79], v[100:103], v[32:35]
    ds_read_b64 v[156:157], v50 offset:3776
    v_mfma_f32_16x16x32_bf16 v[36:39], v[76:79], v[104:107], v[36:39]
    ds_read_b64 v[158:159], v50 offset:3784
    s_waitcnt lgkmcnt(0)
    v_mfma_f32_16x16x32_bf16 v[40:43], v[76:79], v[108:111], v[40:43]
    v_mfma_f32_16x16x32_bf16 v[44:47], v[76:79], v[112:115], v[44:47]
    v_mfma_f32_16x16x32_bf16 v[32:35], v[80:83], v[96:99], v[32:35]
    v_mfma_f32_16x16x32_bf16 v[36:39], v[80:83], v[100:103], v[36:39]
    v_mfma_f32_16x16x32_bf16 v[40:43], v[80:83], v[104:107], v[40:43]
    v_mfma_f32_16x16x32_bf16 v[44:47], v[80:83], v[108:111], v[44:47]
    v_mfma_f32_16x16x32_bf16 v[36:39], v[84:87], v[96:99], v[36:39]
    v_mfma_f32_16x16x32_bf16 v[40:43], v[84:87], v[100:103], v[40:43]
    v_mfma_f32_16x16x32_bf16 v[44:47], v[84:87], v[104:107], v[44:47]
    v_mfma_f32_16x16x32_bf16 v[40:43], v[88:91], v[96:99], v[40:43]
    v_mfma_f32_16x16x32_bf16 v[44:47], v[88:91], v[100:103], v[44:47]
    v_mfma_f32_16x16x32_bf16 v[44:47], v[92:95], v[96:99], v[44:47]
    s_waitcnt lgkmcnt(0)
    v_mfma_f32_16x16x32_bf16 v[16:19], v[128:131], v[160:163], v[16:19]
    v_mfma_f32_16x16x32_bf16 v[20:23], v[128:131], v[164:167], v[20:23]
    v_mfma_f32_16x16x32_bf16 v[24:27], v[128:131], v[168:171], v[24:27]
    v_mfma_f32_16x16x32_bf16 v[28:31], v[128:131], v[172:175], v[28:31]
    v_mfma_f32_16x16x32_bf16 v[32:35], v[128:131], v[176:179], v[32:35]
    v_mfma_f32_16x16x32_bf16 v[36:39], v[128:131], v[180:183], v[36:39]
    v_mfma_f32_16x16x32_bf16 v[40:43], v[128:131], v[184:187], v[40:43]
    v_mfma_f32_16x16x32_bf16 v[44:47], v[128:131], v[188:191], v[44:47]
    v_mfma_f32_16x16x32_bf16 v[20:23], v[132:135], v[160:163], v[20:23]
    v_mfma_f32_16x16x32_bf16 v[24:27], v[132:135], v[164:167], v[24:27]
    v_mfma_f32_16x16x32_bf16 v[28:31], v[132:135], v[168:171], v[28:31]
    v_mfma_f32_16x16x32_bf16 v[32:35], v[132:135], v[172:175], v[32:35]
    s_waitcnt lgkmcnt(0)
    v_mfma_f32_16x16x32_bf16 v[36:39], v[132:135], v[176:179], v[36:39]
    v_mfma_f32_16x16x32_bf16 v[40:43], v[132:135], v[180:183], v[40:43]
    v_mfma_f32_16x16x32_bf16 v[44:47], v[132:135], v[184:187], v[44:47]
    v_mfma_f32_16x16x32_bf16 v[24:27], v[136:139], v[160:163], v[24:27]
    v_mfma_f32_16x16x32_bf16 v[28:31], v[136:139], v[164:167], v[28:31]
    v_mfma_f32_16x16x32_bf16 v[32:35], v[136:139], v[168:171], v[32:35]
    v_mfma_f32_16x16x32_bf16 v[36:39], v[136:139], v[172:175], v[36:39]
    v_mfma_f32_16x16x32_bf16 v[40:43], v[136:139], v[176:179], v[40:43]
    v_mfma_f32_16x16x32_bf16 v[44:47], v[136:139], v[180:183], v[44:47]
    v_mfma_f32_16x16x32_bf16 v[28:31], v[140:143], v[160:163], v[28:31]
    v_mfma_f32_16x16x32_bf16 v[32:35], v[140:143], v[164:167], v[32:35]
    v_mfma_f32_16x16x32_bf16 v[36:39], v[140:143], v[168:171], v[36:39]
    s_waitcnt lgkmcnt(0)
    v_mfma_f32_16x16x32_bf16 v[40:43], v[140:143], v[172:175], v[40:43]
    v_mfma_f32_16x16x32_bf16 v[44:47], v[140:143], v[176:179], v[44:47]
    v_mfma_f32_16x16x32_bf16 v[32:35], v[144:147], v[160:163], v[32:35]
    v_mfma_f32_16x16x32_bf16 v[36:39], v[144:147], v[164:167], v[36:39]
    v_mfma_f32_16x16x32_bf16 v[40:43], v[144:147], v[168:171], v[40:43]
    v_mfma_f32_16x16x32_bf16 v[44:47], v[144:147], v[172:175], v[44:47]
    v_mfma_f32_16x16x32_bf16 v[36:39], v[148:151], v[160:163], v[36:39]
    v_mfma_f32_16x16x32_bf16 v[40:43], v[148:151], v[164:167], v[40:43]
    v_mfma_f32_16x16x32_bf16 v[44:47], v[148:151], v[168:171], v[44:47]
    v_mfma_f32_16x16x32_bf16 v[40:43], v[152:155], v[160:163], v[40:43]
    v_mfma_f32_16x16x32_bf16 v[44:47], v[152:155], v[164:167], v[44:47]
    v_mfma_f32_16x16x32_bf16 v[44:47], v[156:159], v[160:163], v[44:47]
    s_waitcnt lgkmcnt(0)
    ds_read_b64 v[80:81], v57 offset:1536
    ds_read_b64 v[82:83], v57 offset:1024
    ds_read_b64 v[84:85], v57 offset:512
    ds_read_b64 v[86:87], v57 offset:0
    v_lshlrev_b32 v60, 16, v60
    s_cmp_eq_u32 s27, 0
    s_cbranch_scc0 F_h1
    ds_write_b128 v54, v[32:35] offset:0
    ds_write_b128 v54, v[36:39] offset:1024
    ds_write_b128 v54, v[40:43] offset:2048
    ds_write_b128 v54, v[44:47] offset:3072
    s_cmp_lg_u32 s38, 0
    s_cbranch_scc1 F_z_ok
    s_lshl_b32 s56, s25, 13
    s_add_u32 s56, s56, 21495808
    s_add_u32 s57, s56, 4096
    v_lshlrev_b32 v11, 6, v1
    s_mov_b32 s58, 0
F_z_p:
    buffer_load_dwordx2 v[12:13], v11, s[20:23], s56 offen sc1
    buffer_load_dwordx2 v[14:15], v11, s[20:23], s57 offen sc1
    s_waitcnt vmcnt(0)
    v_xor_b32 v12, v12, v58
    v_xor_b32 v13, v13, v59
    v_or_b32 v12, v12, v13
    v_xor_b32 v14, v14, v58
    v_xor_b32 v15, v15, v59
    v_or3_b32 v12, v12, v14, v15
    v_cmp_ne_u32 vcc, 0, v12
    s_nop 1
    s_cbranch_vccz F_z_ok
    s_add_u32 s58, s58, 1
    s_sleep 4
    s_cmp_gt_u32 s58, 0x100000
    s_cbranch_scc0 F_z_p
F_z_ok:
    s_waitcnt lgkmcnt(0)
    s_barrier
    ds_read_b128 v[64:67], v55 offset:0
    ds_read_b128 v[68:71], v55 offset:1024
    ds_read_b128 v[72:75], v55 offset:2048
    ds_read_b128 v[76:79], v55 offset:3072
    v_and_b32 v96, 0xffff0000, v81
    v_lshlrev_b32 v97, 16, v81
    v_and_b32 v98, 0xffff0000, v80
    v_lshlrev_b32 v99, 16, v80
    v_fmac_f32 v16, v96, v60
    v_fmac_f32 v17, v97, v60
    v_fmac_f32 v18, v98, v60
    v_fmac_f32 v19, v99, v60
    v_and_b32 v100, 0xffff0000, v83
    v_lshlrev_b32 v101, 16, v83
    v_and_b32 v102, 0xffff0000, v82
    v_lshlrev_b32 v103, 16, v82
    v_fmac_f32 v20, v100, v60
    v_fmac_f32 v21, v101, v60
    v_fmac_f32 v22, v102, v60
    v_fmac_f32 v23, v103, v60
    v_and_b32 v104, 0xffff0000, v85
    v_lshlrev_b32 v105, 16, v85
    v_and_b32 v106, 0xffff0000, v84
    v_lshlrev_b32 v107, 16, v84
    v_fmac_f32 v24, v104, v60
    v_fmac_f32 v25, v105, v60
    v_fmac_f32 v26, v106, v60
    v_fmac_f32 v27, v107, v60
    v_and_b32 v108, 0xffff0000, v87
    v_lshlrev_b32 v109, 16, v87
    v_and_b32 v110, 0xffff0000, v86
    v_lshlrev_b32 v111, 16, v86
    v_fmac_f32 v28, v108, v60
    v_fmac_f32 v29, v109, v60
    v_fmac_f32 v30, v110, v60
    v_fmac_f32 v31, v111, v60
    s_waitcnt lgkmcnt(0)
    v_add_f32 v16, v16, v64
    v_add_f32 v17, v17, v65
    v_add_f32 v18, v18, v66
    v_add_f32 v19, v19, v67
    v_cvt_pk_bf16_f32 v112, v16, v17
    v_cvt_pk_bf16_f32 v113, v18, v19
    ds_write_b64 v56, v[112:113] offset:0
    v_add_f32 v20, v20, v68
    v_add_f32 v21, v21, v69
    v_add_f32 v22, v22, v70
    v_add_f32 v23, v23, v71
    v_cvt_pk_bf16_f32 v114, v20, v21
    v_cvt_pk_bf16_f32 v115, v22, v23
    ds_write_b64 v56, v[114:115] offset:512
    v_add_f32 v24, v24, v72
    v_add_f32 v25, v25, v73
    v_add_f32 v26, v26, v74
    v_add_f32 v27, v27, v75
    v_cvt_pk_bf16_f32 v116, v24, v25
    v_cvt_pk_bf16_f32 v117, v26, v27
    ds_write_b64 v56, v[116:117] offset:1024
    v_add_f32 v28, v28, v76
    v_add_f32 v29, v29, v77
    v_add_f32 v30, v30, v78
    v_add_f32 v31, v31, v79
    v_cvt_pk_bf16_f32 v118, v28, v29
    v_cvt_pk_bf16_f32 v119, v30, v31
    ds_write_b64 v56, v[118:119] offset:1536
    s_branch F_hj
F_h1:
    s_nop 7
    ds_write_b128 v54, v[16:19] offset:0
    ds_write_b128 v54, v[20:23] offset:1024
    ds_write_b128 v54, v[24:27] offset:2048
    ds_write_b128 v54, v[28:31] offset:3072
    s_waitcnt lgkmcnt(0)
    s_barrier
    ds_read_b128 v[64:67], v55 offset:0
    ds_read_b128 v[68:71], v55 offset:1024
    ds_read_b128 v[72:75], v55 offset:2048
    ds_read_b128 v[76:79], v55 offset:3072
    v_and_b32 v96, 0xffff0000, v81
    v_lshlrev_b32 v97, 16, v81
    v_and_b32 v98, 0xffff0000, v80
    v_lshlrev_b32 v99, 16, v80
    v_fmac_f32 v32, v96, v60
    v_fmac_f32 v33, v97, v60
    v_fmac_f32 v34, v98, v60
    v_fmac_f32 v35, v99, v60
    v_and_b32 v100, 0xffff0000, v83
    v_lshlrev_b32 v101, 16, v83
    v_and_b32 v102, 0xffff0000, v82
    v_lshlrev_b32 v103, 16, v82
    v_fmac_f32 v36, v100, v60
    v_fmac_f32 v37, v101, v60
    v_fmac_f32 v38, v102, v60
    v_fmac_f32 v39, v103, v60
    v_and_b32 v104, 0xffff0000, v85
    v_lshlrev_b32 v105, 16, v85
    v_and_b32 v106, 0xffff0000, v84
    v_lshlrev_b32 v107, 16, v84
    v_fmac_f32 v40, v104, v60
    v_fmac_f32 v41, v105, v60
    v_fmac_f32 v42, v106, v60
    v_fmac_f32 v43, v107, v60
    v_and_b32 v108, 0xffff0000, v87
    v_lshlrev_b32 v109, 16, v87
    v_and_b32 v110, 0xffff0000, v86
    v_lshlrev_b32 v111, 16, v86
    v_fmac_f32 v44, v108, v60
    v_fmac_f32 v45, v109, v60
    v_fmac_f32 v46, v110, v60
    v_fmac_f32 v47, v111, v60
    s_waitcnt lgkmcnt(0)
    v_add_f32 v32, v32, v64
    v_add_f32 v33, v33, v65
    v_add_f32 v34, v34, v66
    v_add_f32 v35, v35, v67
    v_cvt_pk_bf16_f32 v112, v32, v33
    v_cvt_pk_bf16_f32 v113, v34, v35
    ds_write_b64 v56, v[112:113] offset:0
    v_add_f32 v36, v36, v68
    v_add_f32 v37, v37, v69
    v_add_f32 v38, v38, v70
    v_add_f32 v39, v39, v71
    v_cvt_pk_bf16_f32 v114, v36, v37
    v_cvt_pk_bf16_f32 v115, v38, v39
    ds_write_b64 v56, v[114:115] offset:512
    v_add_f32 v40, v40, v72
    v_add_f32 v41, v41, v73
    v_add_f32 v42, v42, v74
    v_add_f32 v43, v43, v75
    v_cvt_pk_bf16_f32 v116, v40, v41
    v_cvt_pk_bf16_f32 v117, v42, v43
    ds_write_b64 v56, v[116:117] offset:1024
    v_add_f32 v44, v44, v76
    v_add_f32 v45, v45, v77
    v_add_f32 v46, v46, v78
    v_add_f32 v47, v47, v79
    v_cvt_pk_bf16_f32 v118, v44, v45
    v_cvt_pk_bf16_f32 v119, v46, v47
    ds_write_b64 v56, v[118:119] offset:1536
F_hj:
    v_add_u32 v11, s53, v2
    ds_read_b128 v[120:123], v11
    ds_read_b128 v[124:127], v11 offset:1024
    s_waitcnt lgkmcnt(0)
    buffer_store_dwordx4 v[120:123], v2, s[20:23], s43 offen sc1
    buffer_store_dwordx4 v[124:127], v2, s[20:23], s43 offen offset:1024 sc1
    s_barrier
    s_mov_b32 s12, s96
    s_and_b32 s13, s97, 0xffff
    s_mov_b32 s14, 802816
    s_mov_b32 s15, 0x20000
    s_mov_b32 s16, s98
    s_and_b32 s17, s99, 0xffff
    s_mov_b32 s18, 1835008
    s_mov_b32 s19, 0x20000
    v_lshrrev_b32 v11, 3, v1
    v_and_b32 v12, 7, v1
    v_bfe_u32 v13, v1, 4, 1
    v_mul_u32_u24 v14, 896, v11
    v_lshlrev_b32 v13, 2, v13
    v_xor_b32 v15, v12, v13
    v_lshl_add_u32 v5, v15, 4, v14
    s_mul_i32 s34, s38, 7168
    s_lshl_b32 s35, s25, 7
    s_add_u32 s34, s34, s35
    s_lshl_b32 s37, s38, 10
    s_add_u32 s37, s37, 49152
    s_lshl_b32 s48, s26, 1
    s_add_u32 s48, s48, s27
    v_and_b32 v11, 31, v1
    v_mul_u32_u24 v12, 896, v11
    v_lshrrev_b32 v13, 5, v1
    v_lshl_add_u32 v3, v13, 4, v12
    s_mul_i32 s49, s48, 28672
    s_lshl_b32 s50, s25, 1
    s_add_u32 s50, s50, s39
    s_lshl_b32 s51, s50, 6
    s_add_u32 s49, s49, s51
    v_lshlrev_b32 v6, 3, v11
    s_lshl_b32 s51, s48, 8
    s_add_u32 s51, s51, 22020096
    v_lshrrev_b32 v7, 2, v1
    v_mul_u32_u24 v7, 4224, v7
    v_and_b32 v13, 3, v1
    v_lshl_add_u32 v7, v13, 4, v7
    s_mul_i32 s52, s50, 135168
    s_lshl_b32 s54, s48, 6
    s_add_u32 s52, s52, s54
    s_add_u32 s52, s52, 16777216
    v_lshrrev_b32 v12, 5, v1
    v_bfe_u32 v13, v1, 2, 2
    v_lshl_add_u32 v14, v12, 2, v13
    v_lshlrev_b32 v14, 6, v14
    v_bfe_u32 v15, v1, 4, 1
    v_lshl_add_u32 v14, v15, 5, v14
    v_and_b32 v15, 3, v1
    v_lshl_add_u32 v14, v15, 3, v14
    v_add_u32 v8, s53, v14
    s_lshl_b32 s54, s38, 12
    s_add_u32 s54, s54, 49152
    v_add_u32 v9, s54, v2
    v_add_u32 v10, 57344, v9
    v_and_b32 v50, 31, v1
    v_lshlrev_b32 v50, 7, v50
    s_lshl_b32 s56, s50, 12
    s_lshr_b32 s55, s48, 5
    s_lshl_b32 s55, s55, 6
    s_add_u32 s56, s56, s55
    s_add_u32 s56, s56, 196608
    v_add_u32 v50, s56, v50
    s_lshl_b32 s56, s48, 6
    v_mov_b32 v51, s56
    v_cmp_gt_u32 vcc, 32, v1
    s_nop 1
    v_cndmask_b32 v50, v51, v50, vcc
    s_mov_b32 s56, 21495808
    s_lshl_b32 s55, s2, 2
    s_add_u32 s55, s55, s38
    s_lshl_b32 s55, s55, 6
    s_add_u32 s55, s55, 21692416
    v_mov_b32 v52, 0
    s_waitcnt vmcnt(0)
    s_mov_b64 exec, 1
    buffer_store_dwordx2 v[58:59], v52, s[20:23], s55 offen sc1
    s_mov_b64 exec, -1
    s_barrier
    s_barrier
    buffer_load_dwordx2 v[28:29], v50, s[20:23], s56 offen sc1
    s_barrier
    s_waitcnt vmcnt(0)
    v_xor_b32 v28, v28, v58
    v_xor_b32 v29, v29, v59
    v_or_b32 v28, v28, v29
    v_cmp_ne_u32 vcc, 0, v28
    s_nop 1
    s_cbranch_vccz F_y_ok
    s_mov_b32 s58, 0
F_y_p:
    buffer_load_dwordx2 v[28:29], v50, s[20:23], s56 offen sc1
    s_waitcnt vmcnt(0)
    v_xor_b32 v28, v28, v58
    v_xor_b32 v29, v29, v59
    v_or_b32 v28, v28, v29
    v_cmp_ne_u32 vcc, 0, v28
    s_nop 1
    s_cbranch_vccz F_y_ok
    s_add_u32 s58, s58, 1
    s_sleep 4
    s_cmp_gt_u32 s58, 0x100000
    s_cbranch_scc0 F_y_p
F_y_ok:
    s_mov_b32 m0, s53
    s_add_u32 s33, s52, 67584
    buffer_load_dwordx4 v7, s[20:23], s52 offen sc1 lds
    s_add_u32 m0, s53, 1024
    s_nop 0
    buffer_load_dwordx4 v7, s[20:23], s33 offen sc1 lds
    v_and_b32 v11, 31, v1
    v_lshlrev_b32 v11, 6, v11
    v_lshrrev_b32 v12, 5, v1
    v_lshl_add_u32 v11, v12, 3, v11
    v_add_u32 v11, s100, v11
    ds_read_b64 v[64:65], v11
    ds_read_b64 v[66:67], v11 offset:16
    ds_read_b64 v[68:69], v11 offset:32
    ds_read_b64 v[70:71], v11 offset:48
    buffer_load_dwordx2 v[72:73], v6, s[20:23], s51 offen sc1
    s_barrier
    ds_write_b128 v63, v[192:195] offset:16384
    ds_write_b128 v63, v[196:199] offset:17408
    ds_write_b128 v63, v[200:203] offset:24576
    ds_write_b128 v63, v[204:207] offset:25600
    ds_write_b128 v63, v[208:211] offset:32768
    ds_write_b128 v63, v[212:215] offset:33792
    ds_write_b128 v62, v[216:219] offset:0
    ds_write_b128 v62, v[220:223] offset:1024
    s_waitcnt vmcnt(0) lgkmcnt(0)
    ds_read_b64_tr_b16 v[76:77], v8 offset:0
    ds_read_b64_tr_b16 v[78:79], v8 offset:512
    ds_read_b64_tr_b16 v[80:81], v8 offset:1024
    ds_read_b64_tr_b16 v[82:83], v8 offset:1536
    v_lshlrev_b32 v16, 16, v64
    v_and_b32 v17, 0xffff0000, v64
    v_lshlrev_b32 v18, 16, v65
    v_and_b32 v19, 0xffff0000, v65
    v_lshlrev_b32 v20, 16, v66
    v_and_b32 v21, 0xffff0000, v66
    v_lshlrev_b32 v22, 16, v67
    v_and_b32 v23, 0xffff0000, v67
    v_lshlrev_b32 v24, 16, v68
    v_and_b32 v25, 0xffff0000, v68
    v_lshlrev_b32 v26, 16, v69
    v_and_b32 v27, 0xffff0000, v69
    v_lshlrev_b32 v28, 16, v70
    v_and_b32 v29, 0xffff0000, v70
    v_lshlrev_b32 v30, 16, v71
    v_and_b32 v31, 0xffff0000, v71
    v_sub_f32 v160, v16, v72
    v_sub_f32 v161, v17, v72
    v_sub_f32 v162, v18, v72
    v_sub_f32 v163, v19, v72
    v_sub_f32 v164, v20, v72
    v_sub_f32 v165, v21, v72
    v_sub_f32 v166, v22, v72
    v_sub_f32 v167, v23, v72
    v_sub_f32 v168, v24, v72
    v_sub_f32 v169, v25, v72
    v_sub_f32 v170, v26, v72
    v_sub_f32 v171, v27, v72
    v_sub_f32 v172, v28, v72
    v_sub_f32 v173, v29, v72
    v_sub_f32 v174, v30, v72
    v_sub_f32 v175, v31, v72
    v_mul_f32 v160, v160, v73
    v_mul_f32 v161, v161, v73
    v_mul_f32 v162, v162, v73
    v_mul_f32 v163, v163, v73
    v_mul_f32 v164, v164, v73
    v_mul_f32 v165, v165, v73
    v_mul_f32 v166, v166, v73
    v_mul_f32 v167, v167, v73
    v_mul_f32 v168, v168, v73
    v_mul_f32 v169, v169, v73
    v_mul_f32 v170, v170, v73
    v_mul_f32 v171, v171, v73
    v_mul_f32 v172, v172, v73
    v_mul_f32 v173, v173, v73
    v_mul_f32 v174, v174, v73
    v_mul_f32 v175, v175, v73
    v_mov_b32 v176, 0xbfb8aa3b
    v_mov_b32 v178, 1.0
    s_waitcnt lgkmcnt(0)
    v_lshlrev_b32 v32, 16, v76
    v_and_b32 v33, 0xffff0000, v76
    v_lshlrev_b32 v34, 16, v77
    v_and_b32 v35, 0xffff0000, v77
    v_lshlrev_b32 v36, 16, v78
    v_and_b32 v37, 0xffff0000, v78
    v_lshlrev_b32 v38, 16, v79
    v_and_b32 v39, 0xffff0000, v79
    v_lshlrev_b32 v40, 16, v80
    v_and_b32 v41, 0xffff0000, v80
    v_lshlrev_b32 v42, 16, v81
    v_and_b32 v43, 0xffff0000, v81
    v_lshlrev_b32 v44, 16, v82
    v_and_b32 v45, 0xffff0000, v82
    v_lshlrev_b32 v46, 16, v83
    v_and_b32 v47, 0xffff0000, v83
    v_mul_f32 v32, v32, v160
    v_mul_f32 v33, v33, v161
    v_mul_f32 v34, v34, v162
    v_mul_f32 v35, v35, v163
    v_mul_f32 v36, v36, v164
    v_mul_f32 v37, v37, v165
    v_mul_f32 v38, v38, v166
    v_mul_f32 v39, v39, v167
    v_mul_f32 v40, v40, v168
    v_mul_f32 v41, v41, v169
    v_mul_f32 v42, v42, v170
    v_mul_f32 v43, v43, v171
    v_mul_f32 v44, v44, v172
    v_mul_f32 v45, v45, v173
    v_mul_f32 v46, v46, v174
    v_mul_f32 v47, v47, v175
    s_waitcnt lgkmcnt(0)
    s_barrier
    ds_write_b128 v62, v[224:227] offset:8192
    ds_write_b128 v62, v[228:231] offset:9216
    ds_write_b128 v62, v[232:235] offset:16384
    ds_write_b128 v62, v[236:239] offset:17408
    ds_write_b128 v62, v[240:243] offset:24576
    ds_write_b128 v62, v[244:247] offset:25600
    ds_write_b128 v62, v[248:251] offset:32768
    ds_write_b128 v62, v[252:255] offset:33792
    s_waitcnt lgkmcnt(0)
    s_barrier
    s_add_u32 m0, s37, 0
    s_add_u32 s33, s34, 0
    buffer_load_dwordx4 v5, s[12:15], s33 offen lds
    s_add_u32 m0, s37, 4096
    s_add_u32 s33, s34, 28672
    buffer_load_dwordx4 v5, s[12:15], s33 offen lds
    s_add_u32 m0, s37, 8192
    s_add_u32 s33, s34, 57344
    buffer_load_dwordx4 v5, s[12:15], s33 offen lds
    s_add_u32 m0, s37, 12288
    s_add_u32 s33, s34, 86016
    buffer_load_dwordx4 v5, s[12:15], s33 offen lds
    s_add_u32 m0, s37, 16384
    s_add_u32 s33, s34, 114688
    buffer_load_dwordx4 v5, s[12:15], s33 offen lds
    s_add_u32 m0, s37, 20480
    s_add_u32 s33, s34, 143360
    buffer_load_dwordx4 v5, s[12:15], s33 offen lds
    s_add_u32 m0, s37, 24576
    s_add_u32 s33, s34, 172032
    buffer_load_dwordx4 v5, s[12:15], s33 offen lds
    s_add_u32 m0, s37, 28672
    s_add_u32 s33, s34, 200704
    buffer_load_dwordx4 v5, s[12:15], s33 offen lds
    s_add_u32 m0, s37, 32768
    s_add_u32 s33, s34, 229376
    buffer_load_dwordx4 v5, s[12:15], s33 offen lds
    s_add_u32 m0, s37, 36864
    s_add_u32 s33, s34, 258048
    buffer_load_dwordx4 v5, s[12:15], s33 offen lds
    s_add_u32 m0, s37, 40960
    s_add_u32 s33, s34, 286720
    buffer_load_dwordx4 v5, s[12:15], s33 offen lds
    s_add_u32 m0, s37, 45056
    s_add_u32 s33, s34, 315392
    buffer_load_dwordx4 v5, s[12:15], s33 offen lds
    s_add_u32 m0, s37, 49152
    s_add_u32 s33, s34, 344064
    buffer_load_dwordx4 v5, s[12:15], s33 offen lds
    s_add_u32 m0, s37, 53248
    s_add_u32 s33, s34, 372736
    buffer_load_dwordx4 v5, s[12:15], s33 offen lds
    s_add_u32 m0, s37, 57344
    s_add_u32 s33, s34, 401408
    buffer_load_dwordx4 v5, s[12:15], s33 offen lds
    s_add_u32 m0, s37, 61440
    s_add_u32 s33, s34, 430080
    buffer_load_dwordx4 v5, s[12:15], s33 offen lds
    s_add_u32 m0, s37, 65536
    s_add_u32 s33, s34, 458752
    buffer_load_dwordx4 v5, s[12:15], s33 offen lds
    s_add_u32 m0, s37, 69632
    s_add_u32 s33, s34, 487424
    buffer_load_dwordx4 v5, s[12:15], s33 offen lds
    s_add_u32 m0, s37, 73728
    s_add_u32 s33, s34, 516096
    buffer_load_dwordx4 v5, s[12:15], s33 offen lds
    s_add_u32 m0, s37, 77824
    s_add_u32 s33, s34, 544768
    buffer_load_dwordx4 v5, s[12:15], s33 offen lds
    s_add_u32 m0, s37, 81920
    s_add_u32 s33, s34, 573440
    buffer_load_dwordx4 v5, s[12:15], s33 offen lds
    s_add_u32 m0, s37, 86016
    s_add_u32 s33, s34, 602112
    buffer_load_dwordx4 v5, s[12:15], s33 offen lds
    s_add_u32 m0, s37, 90112
    s_add_u32 s33, s34, 630784
    buffer_load_dwordx4 v5, s[12:15], s33 offen lds
    s_add_u32 m0, s37, 94208
    s_add_u32 s33, s34, 659456
    buffer_load_dwordx4 v5, s[12:15], s33 offen lds
    s_add_u32 m0, s37, 98304
    s_add_u32 s33, s34, 688128
    buffer_load_dwordx4 v5, s[12:15], s33 offen lds
    s_add_u32 m0, s37, 102400
    s_add_u32 s33, s34, 716800
    buffer_load_dwordx4 v5, s[12:15], s33 offen lds
    s_add_u32 m0, s37, 106496
    s_add_u32 s33, s34, 745472
    buffer_load_dwordx4 v5, s[12:15], s33 offen lds
    s_add_u32 m0, s37, 110592
    s_add_u32 s33, s34, 774144
    buffer_load_dwordx4 v5, s[12:15], s33 offen lds
    s_waitcnt vmcnt(0)
    s_barrier
    s_lshl_b32 s33, s38, 11
    v_and_b32 v11, 31, v1
    v_lshlrev_b32 v12, 6, v11
    v_lshrrev_b32 v13, 5, v1
    v_lshl_add_u32 v12, v13, 3, v12
    v_bfe_u32 v13, v1, 1, 2
    v_lshl_add_u32 v12, v13, 4, v12
    v_add_u32 v52, s33, v12
    v_xor_b32 v53, 16, v52
    v_xor_b32 v54, 32, v52
    v_xor_b32 v55, 48, v52
    v_bfe_u32 v13, v1, 3, 2
    v_lshlrev_b32 v13, 4, v13
    v_xor_b32 v56, v13, v2
    v_add_u32 v56, s33, v56
    v_lshrrev_b32 v11, 2, v1
    v_mul_u32_u24 v11, 896, v11
    v_and_b32 v12, 3, v1
    v_lshl_add_u32 v57, v12, 4, v11
    s_barrier
    ds_read_b128 v[96:99], v9 offset:0
    ds_read_b128 v[100:103], v9 offset:1024
    ds_read_b128 v[104:107], v9 offset:2048
    ds_read_b128 v[108:111], v9 offset:3072
    ds_read_b128 v[112:115], v9 offset:28672
    ds_read_b128 v[116:119], v9 offset:29696
    ds_read_b128 v[120:123], v9 offset:30720
    ds_read_b128 v[124:127], v9 offset:31744
    ds_read_b128 v[128:131], v10 offset:0
    ds_read_b128 v[132:135], v10 offset:1024
    ds_read_b128 v[136:139], v10 offset:2048
    ds_read_b128 v[140:143], v10 offset:3072
    s_waitcnt lgkmcnt(4)
    ds_read_b128 v[144:147], v10 offset:28672
    ds_read_b128 v[148:151], v10 offset:29696
    ds_read_b128 v[152:155], v10 offset:30720
    ds_read_b128 v[156:159], v10 offset:31744
    v_pk_add_f32 v[96:97], v[96:97], v[112:113]
    v_pk_add_f32 v[98:99], v[98:99], v[114:115]
    v_pk_add_f32 v[100:101], v[100:101], v[116:117]
    v_pk_add_f32 v[102:103], v[102:103], v[118:119]
    v_pk_add_f32 v[104:105], v[104:105], v[120:121]
    v_pk_add_f32 v[106:107], v[106:107], v[122:123]
    v_pk_add_f32 v[108:109], v[108:109], v[124:125]
    v_pk_add_f32 v[110:111], v[110:111], v[126:127]
    s_waitcnt lgkmcnt(4)
    v_pk_add_f32 v[96:97], v[96:97], v[128:129]
    v_pk_add_f32 v[98:99], v[98:99], v[130:131]
    v_pk_add_f32 v[100:101], v[100:101], v[132:133]
    v_pk_add_f32 v[102:103], v[102:103], v[134:135]
    v_pk_add_f32 v[104:105], v[104:105], v[136:137]
    v_pk_add_f32 v[106:107], v[106:107], v[138:139]
    v_pk_add_f32 v[108:109], v[108:109], v[140:141]
    v_pk_add_f32 v[110:111], v[110:111], v[142:143]
    s_waitcnt lgkmcnt(0)
    v_pk_add_f32 v[96:97], v[96:97], v[144:145]
    v_pk_add_f32 v[98:99], v[98:99], v[146:147]
    v_pk_add_f32 v[100:101], v[100:101], v[148:149]
    v_pk_add_f32 v[102:103], v[102:103], v[150:151]
    v_pk_add_f32 v[104:105], v[104:105], v[152:153]
    v_pk_add_f32 v[106:107], v[106:107], v[154:155]
    v_pk_add_f32 v[108:109], v[108:109], v[156:157]
    v_pk_add_f32 v[110:111], v[110:111], v[158:159]
    v_pk_mul_f32 v[160:161], v[96:97], v[176:177] op_sel_hi:[1,0]
    v_pk_mul_f32 v[162:163], v[98:99], v[176:177] op_sel_hi:[1,0]
    v_pk_mul_f32 v[164:165], v[100:101], v[176:177] op_sel_hi:[1,0]
    v_pk_mul_f32 v[166:167], v[102:103], v[176:177] op_sel_hi:[1,0]
    v_pk_mul_f32 v[168:169], v[104:105], v[176:177] op_sel_hi:[1,0]
    v_pk_mul_f32 v[170:171], v[106:107], v[176:177] op_sel_hi:[1,0]
    v_pk_mul_f32 v[172:173], v[108:109], v[176:177] op_sel_hi:[1,0]
    v_pk_mul_f32 v[174:175], v[110:111], v[176:177] op_sel_hi:[1,0]
    v_exp_f32 v160, v160
    v_exp_f32 v161, v161
    v_exp_f32 v162, v162
    v_exp_f32 v163, v163
    v_exp_f32 v164, v164
    v_exp_f32 v165, v165
    v_exp_f32 v166, v166
    v_exp_f32 v167, v167
    v_exp_f32 v168, v168
    v_exp_f32 v169, v169
    v_exp_f32 v170, v170
    v_exp_f32 v171, v171
    v_exp_f32 v172, v172
    v_exp_f32 v173, v173
    v_exp_f32 v174, v174
    v_exp_f32 v175, v175
    v_pk_mul_f32 v[96:97], v[96:97], v[32:33]
    v_pk_mul_f32 v[98:99], v[98:99], v[34:35]
    v_pk_mul_f32 v[100:101], v[100:101], v[36:37]
    v_pk_mul_f32 v[102:103], v[102:103], v[38:39]
    v_pk_mul_f32 v[104:105], v[104:105], v[40:41]
    v_pk_mul_f32 v[106:107], v[106:107], v[42:43]
    v_pk_mul_f32 v[108:109], v[108:109], v[44:45]
    v_pk_mul_f32 v[110:111], v[110:111], v[46:47]
    v_pk_add_f32 v[160:161], v[160:161], v[178:179] op_sel_hi:[1,0]
    v_pk_add_f32 v[162:163], v[162:163], v[178:179] op_sel_hi:[1,0]
    v_pk_add_f32 v[164:165], v[164:165], v[178:179] op_sel_hi:[1,0]
    v_pk_add_f32 v[166:167], v[166:167], v[178:179] op_sel_hi:[1,0]
    v_pk_add_f32 v[168:169], v[168:169], v[178:179] op_sel_hi:[1,0]
    v_pk_add_f32 v[170:171], v[170:171], v[178:179] op_sel_hi:[1,0]
    v_pk_add_f32 v[172:173], v[172:173], v[178:179] op_sel_hi:[1,0]
    v_pk_add_f32 v[174:175], v[174:175], v[178:179] op_sel_hi:[1,0]
    v_rcp_f32 v160, v160
    v_rcp_f32 v161, v161
    v_rcp_f32 v162, v162
    v_rcp_f32 v163, v163
    v_rcp_f32 v164, v164
    v_rcp_f32 v165, v165
    v_rcp_f32 v166, v166
    v_rcp_f32 v167, v167
    v_rcp_f32 v168, v168
    v_rcp_f32 v169, v169
    v_rcp_f32 v170, v170
    v_rcp_f32 v171, v171
    v_rcp_f32 v172, v172
    v_rcp_f32 v173, v173
    v_rcp_f32 v174, v174
    v_rcp_f32 v175, v175
    v_pk_fma_f32 v[160:161], v[160:161], v[96:97], v[16:17]
    v_pk_fma_f32 v[162:163], v[162:163], v[98:99], v[18:19]
    v_pk_fma_f32 v[164:165], v[164:165], v[100:101], v[20:21]
    v_pk_fma_f32 v[166:167], v[166:167], v[102:103], v[22:23]
    v_pk_fma_f32 v[168:169], v[168:169], v[104:105], v[24:25]
    v_pk_fma_f32 v[170:171], v[170:171], v[106:107], v[26:27]
    v_pk_fma_f32 v[172:173], v[172:173], v[108:109], v[28:29]
    v_pk_fma_f32 v[174:175], v[174:175], v[110:111], v[30:31]
    v_cvt_pk_bf16_f32 v64, v160, v161
    v_cvt_pk_bf16_f32 v65, v162, v163
    ds_write_b64 v52, v[64:65]
    v_cvt_pk_bf16_f32 v66, v164, v165
    v_cvt_pk_bf16_f32 v67, v166, v167
    ds_write_b64 v53, v[66:67]
    v_cvt_pk_bf16_f32 v68, v168, v169
    v_cvt_pk_bf16_f32 v69, v170, v171
    ds_write_b64 v54, v[68:69]
    v_cvt_pk_bf16_f32 v70, v172, v173
    v_cvt_pk_bf16_f32 v71, v174, v175
    ds_write_b64 v55, v[70:71]
    ds_read_b128 v[72:75], v56
    ds_read_b128 v[76:79], v56 offset:1024
    s_waitcnt lgkmcnt(1)
    buffer_store_dwordx4 v[72:75], v57, s[16:19], s49 offen
    s_add_u32 s49, s49, 14336
    s_waitcnt lgkmcnt(0)
    buffer_store_dwordx4 v[76:79], v57, s[16:19], s49 offen
    s_endpgm
F_pf:
    s_load_dwordx4 s[4:7], s[0:1], 64
    s_load_dwordx2 s[64:65], s[0:1], 80
    s_load_dwordx4 s[56:59], s[0:1], 8
    s_load_dwordx2 s[60:61], s[0:1], 32
    s_sub_u32 s32, s29, 28
    s_lshl_b32 s32, s32, 3
    s_add_u32 s32, s32, s24
    s_getpc_b64 s[68:69]
Lpc_f:
    s_sub_u32 s68, s68, Lpc_f-recurrent_scan__ssm_conv_h3__mixer_gmlp__prompt_kernel
    s_subb_u32 s69, s69, 0
    s_lshl_b32 s99, s32, 13
    s_add_u32 s99, s99, recurrent_scan__ssm_conv_h3__mixer_gmlp__prompt_kernel-recurrent_scan__ssm_conv_h3__mixer_gmlp__prompt_kernel
    v_lshl_add_u32 v20, v1, 7, s99
    v_min_u32 v20, code_end-recurrent_scan__ssm_conv_h3__mixer_gmlp__prompt_kernel-4, v20
    global_load_dword v21, v20, s[68:69]
    v_lshlrev_b32 v2, 7, v1
    v_lshrrev_b32 v3, 2, v1
    v_and_b32 v4, 3, v1
    v_lshlrev_b32 v4, 7, v4
    v_lshl_add_u32 v3, v3, 12, v4
    s_and_b32 s34, s32, 15
    s_lshl_b32 s34, s34, 16
    s_lshl_b32 s35, s28, 20
    s_add_u32 s34, s34, s35
    s_lshr_b32 s35, s32, 4
    s_lshl_b32 s35, s35, 9
    s_add_u32 s34, s34, s35
    s_xor_b32 s36, s34, 0x100000
    s_lshl_b32 s45, s32, 13
    s_waitcnt lgkmcnt(0)
    s_mov_b32 s16, s4
    s_and_b32 s17, s5, 0xffff
    s_mov_b32 s18, 8388608
    s_mov_b32 s19, 0x20000
    s_mov_b32 s48, s6
    s_and_b32 s49, s7, 0xffff
    s_mov_b32 s50, 4096
    s_mov_b32 s51, 0x20000
    s_mov_b32 s52, s64
    s_and_b32 s53, s65, 0xffff
    s_mov_b32 s54, 802816
    s_mov_b32 s55, 0x20000
    s_mov_b32 s20, s10
    s_and_b32 s21, s11, 0xffff
    s_mov_b32 s22, 22544384
    s_mov_b32 s23, 0x20000
    buffer_load_dword v8, v3, s[16:19], s34 offen offset:1024
    buffer_load_dword v9, v3, s[16:19], s34 offen offset:2048
    buffer_load_dword v10, v3, s[16:19], s34 offen offset:3072
    buffer_load_dword v11, v3, s[16:19], s34 offen offset:0
    buffer_load_dword v12, v2, s[48:51], 0 offen
    buffer_load_dword v24, v2, s[52:55], s45 offen
    s_add_u32 s45, s45, 262144
    buffer_load_dword v25, v2, s[52:55], s45 offen
    s_add_u32 s45, s45, 262144
    buffer_load_dword v26, v2, s[52:55], s45 offen
    s_add_u32 s45, s45, 262144
    buffer_load_dword v27, v2, s[52:55], s45 offen
    s_add_u32 s45, s45, 262144
F_end:
    s_endpgm
code_end:
.section .rodata,"a"
.p2align 6
.amdhsa_kernel recurrent_scan__ssm_conv_h3__mixer_gmlp__prompt_kernel
  .amdhsa_next_free_vgpr 256
  .amdhsa_next_free_sgpr 102
  .amdhsa_accum_offset 256
  .amdhsa_group_segment_fixed_size 0
  .amdhsa_kernarg_size 112
  .amdhsa_user_sgpr_count 2
  .amdhsa_user_sgpr_kernarg_segment_ptr 1
  .amdhsa_system_sgpr_workgroup_id_x 1
.end_amdhsa_kernel
```
